```python
import torch

def _softmax(x, axis=-1):
    return torch.softmax(x, dim=axis)
def _gelu(x):
    return torch.nn.functional.gelu(x, approximate="tanh")
def _silu(x):
    return torch.nn.functional.silu(x)
def _sigmoid(x):
    return torch.sigmoid(x)
def _layernorm(x, axis=-1, eps=1e-5):
    m = x.mean(dim=axis, keepdim=True)
    v = x.var(dim=axis, keepdim=True, unbiased=False)
    return (x - m) / torch.sqrt(v + eps)
def _scatter_add(tgt, idx, src, axis=0):
    return tgt.clone().index_add_(axis, idx, src)
def _segment_sum(src, seg, n):
    out = torch.zeros((n,) + src.shape[1:], dtype=src.dtype)
    return out.index_add_(0, seg, src)
def _pad(x, pw):
    flat = tuple(v for pair in reversed(pw) for v in pair)
    return torch.nn.functional.pad(x, flat)

kernel_name = 'recurrent_scan__spectral_gfnet__dense_activation_relu__prompt'

def setup_inputs():

    _w = (lambda a: (lambda t: t.to(torch.bfloat16) if t.is_floating_point() else t)(torch.as_tensor(a)))
    def _A_setup():
        B, S, D = 1, 2048, 512
        Df = D // 2 + 1
        return {
            "x": _w((lambda *s: torch.randn(*s, dtype=torch.bfloat16) * 0.05)(B, S, D)),
            "w_r": _w((lambda *s: torch.randn(*s, dtype=torch.bfloat16) * 0.2)(S, Df) * 0.02),
            "w_i": _w((lambda *s: torch.randn(*s, dtype=torch.bfloat16) * 0.2)(S, Df) * 0.02),
        }
    _A_in = _A_setup()

    def _B_setup():
        B, S, D, Dff = 1, 2048, 512, 1376
        return {
            "x": _w((lambda *s: torch.randn(*s, dtype=torch.bfloat16) * 0.05)(B, S, D)),
            "w1": _w((lambda *s: torch.randn(*s, dtype=torch.bfloat16) * 0.1)(D, Dff)),
            "w2": _w((lambda *s: torch.randn(*s, dtype=torch.bfloat16) * 0.1)(Dff, D)),
        }
    _B_in = _B_setup()

    return {
        "A_x": _A_in["x"],
        "A_w_r": _A_in["w_r"],
        "A_w_i": _A_in["w_i"],
        "B_x": _B_in["x"],
        "B_w1": _B_in["w1"],
        "B_w2": _B_in["w2"],
    }

def reference(A_x, A_w_r, A_w_i, B_x, B_w1, B_w2):
    def _A_ref(x, w_r, w_i):
        B, S, D = x.shape
        X = (lambda x, axes=(-2,-1): torch.fft.rfft2(x.float(), dim=axes))(x, axes=(-2, -1))
        W = w_r + 1j * w_i
        X = X * W
        y = (lambda x, s, axes=(-2,-1): torch.fft.irfft2(x, s=s, dim=axes).to(torch.bfloat16))(X, (S, D), axes=(-2, -1))
        return y

    def _B_ref(x, w1, w2):
        h = torch.einsum("bsd,df->bsf", x, w1)
        zero = torch.zeros_like(h)
        h = torch.maximum(h, zero)
        return torch.einsum("bsf,fd->bsd", h, w2)

    x = A_x
    xn = _layernorm(x, axis=-1)
    s = _A_ref(xn, A_w_r, A_w_i)
    g = _silu(_B_ref(xn, B_w1, B_w2))
    return x + s * g
```

```asm
; @launch grid=(256,1,1) block=(256,1,1) lds=161280
.amdgcn_target "amdgcn-amd-amdhsa--gfx950"
.text
.globl recurrent_scan__spectral_gfnet__dense_activation_relu__prompt_kernel
.p2align 8
.type recurrent_scan__spectral_gfnet__dense_activation_relu__prompt_kernel,@function
recurrent_scan__spectral_gfnet__dense_activation_relu__prompt_kernel:
    s_load_dwordx2 s[4:5], s[0:1], 0
    s_load_dwordx2 s[8:9], s[0:1], 32
    s_load_dwordx2 s[12:13], s[0:1], 40
    s_load_dwordx2 s[16:17], s[0:1], 64
    s_load_dwordx2 s[20:21], s[0:1], 8
    s_load_dwordx2 s[24:25], s[0:1], 16
    s_load_dwordx2 s[28:29], s[0:1], 48
    v_lshrrev_b32 v3, 6, v0
    s_cmp_ge_u32 s2, 256
    s_cbranch_scc1 L_end
    s_getpc_b64 s[50:51]
L_pc:
    s_add_u32 s48, s50, tbl@rel32@lo+4
    s_addc_u32 s49, s51, tbl@rel32@hi+12
    v_readfirstlane_b32 s3, v3
    v_and_b32 v1, 63, v0
    v_lshlrev_b32 v4, 4, v1
    s_mul_i32 s54, s3, 6144
    s_add_u32 m0, s54, 98304
    v_add_u32 v6, s54, v4
    global_load_lds_dwordx4 v6, s[48:49] offset:0
    global_load_lds_dwordx4 v6, s[48:49] offset:1024
    global_load_lds_dwordx4 v6, s[48:49] offset:2048
    global_load_lds_dwordx4 v6, s[48:49] offset:3072
    s_add_u32 m0, s54, 102400
    v_add_u32 v6, 4096, v6
    s_lshr_b32 s58, s2, 3
    s_and_b32 s54, s58, 3
    s_lshl_b32 s55, s54, 12
    global_load_lds_dwordx4 v6, s[48:49] offset:0
    global_load_lds_dwordx4 v6, s[48:49] offset:1024
    v_lshrrev_b32 v6, 3, v0
    v_lshl_add_u32 v6, v6, 7, s55
    v_min_u32 v6, L_codeend-L_pc-4, v6
    global_load_dword v5, v6, s[50:51]
    v_and_b32 v2, 15, v0
    v_lshrrev_b32 v3, 4, v1
    s_and_b32 s57, s2, 7
    s_lshl2_add_u32 s47, s57, s54
    s_lshr_b32 s52, s2, 5
    s_lshl3_add_u32 s53, s47, s52
    s_lshr_b32 s55, s57, 1
    s_lshl2_add_u32 s59, s55, s54
    s_xor_b32 s54, s54, s57
    s_and_b32 s54, s54, 1
    s_sub_u32 s54, 15, s54
    s_and_b32 s55, s57, 1
    s_mul_i32 s55, s55, 7
    s_add_u32 s60, s55, s52
    s_cmp_eq_u32 s52, 7
    s_cselect_b32 s60, s54, s60
    s_lshl_b32 s62, s3, 13
    s_mov_b32 s6, 2097152
    s_mov_b32 s7, 0x20000
    s_mov_b32 s10, 1409024
    s_mov_b32 s11, 0x20000
    s_mov_b32 s14, 1409024
    s_mov_b32 s15, 0x20000
    s_mov_b32 s18, 32505856
    s_mov_b32 s19, 0x20000
    s_mov_b32 s22, 1052672
    s_mov_b32 s23, 0x20000
    s_mov_b32 s26, 1052672
    s_mov_b32 s27, 0x20000
    s_mov_b32 s30, 2097152
    s_mov_b32 s31, 0x20000
    s_lshl_b32 s54, s3, 11
    s_add_u32 m0, s54, 139776
    s_lshl_b32 s48, s3, 9
    s_add_u32 s48, s48, s53
    s_lshl_b32 s48, s48, 10
    s_add_u32 s49, s48, 261120
    v_lshrrev_b32 v11, 3, v1
    v_and_b32 v10, 7, v1
    v_xor_b32 v10, v10, v3
    v_lshlrev_b32 v11, 10, v11
    v_lshl_add_u32 v6, v10, 4, v11
    v_xor_b32 v7, 64, v6
    v_add_u32 v7, 261120, v7
    v_add_u32 v8, 522240, v6
    v_add_u32 v9, 522240, v7
    s_and_b32 s55, s3, 1
    s_lshr_b32 s54, s3, 1
    s_lshl1_add_u32 s50, s59, s54
    s_lshl_b32 s56, s55, 7
    s_add_u32 s50, s50, s56
    s_lshl_b32 s50, s50, 13
    s_lshl3_add_u32 s51, s54, s55
    s_mul_i32 s51, s51, 11008
    s_mul_i32 s56, s60, 192
    s_add_u32 s51, s51, s56
    s_mul_i32 s54, s59, 88064
    s_mul_i32 s55, s3, 3072
    s_add_u32 s54, s54, s55
    s_mov_b32 s79, 176128
    s_mov_b32 s35, 0x20000
    s_cmp_eq_u32 s60, 15
    s_cselect_b32 s51, s54, s51
    s_cselect_b32 s79, 12288, s79
    s_cselect_b32 s34, 0, s6
    s_xor_b32 s80, s58, s52
    s_and_b32 s80, s80, 1
    s_xor_b32 s54, s80, 0
    s_add_u32 s54, s54, s57
    s_and_b32 s54, s54, 7
    s_lshl_b32 s55, s54, 7
    s_add_u32 s63, s50, s55
    s_mul_i32 s55, s54, s79
    s_add_u32 s71, s51, s55
    s_xor_b32 s54, s80, 1
    s_add_u32 s54, s54, s57
    s_and_b32 s54, s54, 7
    s_lshl_b32 s55, s54, 7
    s_add_u32 s64, s50, s55
    s_mul_i32 s55, s54, s79
    s_add_u32 s72, s51, s55
    s_xor_b32 s54, s80, 2
    s_add_u32 s54, s54, s57
    s_and_b32 s54, s54, 7
    s_lshl_b32 s55, s54, 7
    s_add_u32 s65, s50, s55
    s_mul_i32 s55, s54, s79
    s_add_u32 s73, s51, s55
    s_waitcnt lgkmcnt(0)
    buffer_load_dwordx4 v4, s[4:7], s48 offen lds
    buffer_load_dwordx4 v4, s[4:7], s49 offen offset:1024 lds
    s_mov_b64 s[32:33], s[4:5]
    s_cmp_eq_u32 s60, 15
    s_cselect_b64 s[8:9], s[12:13], s[8:9]
    v_add_u32 v10, 98304, v4
    s_add_u32 m0, s62, 4096
    s_nop 0
    buffer_load_dwordx4 v6, s[32:35], s63 offen offset:0 lds
    buffer_load_dwordx4 v7, s[32:35], s63 offen offset:1024 lds
    buffer_load_dwordx4 v8, s[32:35], s63 offen offset:2048 lds
    buffer_load_dwordx4 v9, s[32:35], s63 offen offset:3072 lds
    v_lshlrev_b32 v103, 16, v1
    s_lshl_b32 s54, s2, 8
    s_add_u32 s54, s54, 14680064
    s_cmp_lt_u32 s2, 32
    s_cselect_b32 s55, 15, 7
    s_cmp_eq_u32 s3, 1
    s_cselect_b32 s54, s54, 32505856
    s_mov_b32 exec_hi, 0
    s_mov_b32 exec_lo, s55
    buffer_store_dword v103, v103, s[16:19], s54 offen offset:124 sc1
    s_mov_b64 exec, -1
    s_mov_b32 s54, 14893056
    buffer_load_dword v11, off, s[16:19], s54 sc1
    s_mov_b64 s[82:83], 0xffff
    s_lshr_b32 s54, s3, 1
    s_mul_i32 s54, s54, 4288
    s_and_b32 s55, s3, 1
    s_lshl3_add_u32 s84, s55, s54
    s_mul_i32 s85, s3, 1056
    s_mul_i32 s86, s3, 4352
    s_lshl_b32 s87, s3, 11
    s_mul_i32 s81, s53, 4112
    s_lshl_b32 s54, s3, 7
    s_add_u32 s81, s81, s54
    s_add_u32 s81, s81, 2
    s_lshl_b32 s88, s53, 14
    s_lshl2_add_u32 s88, s54, s88
    v_and_b32 v124, 1, v3
    v_lshl_add_u32 v124, v124, 10, s53
    v_lshrrev_b32 v115, 1, v2
    v_mul_u32_u24 v116, v115, v124
    v_lshlrev_b32 v124, 8, v115
    v_lshrrev_b32 v115, 5, v1
    v_xor_b32 v115, v115, v1
    v_and_b32 v115, 1, v115
    v_cmp_eq_u32 vcc, 0, v115
    v_cvt_f32_u32 v116, v116
    v_cvt_f32_u32 v124, v124
    v_mul_f32 v120, 0x3a000000, v116
    v_mul_f32 v124, 0x3a000000, v124
    v_add_f32 v121, v120, v124
    v_add_f32 v122, v121, v124
    v_add_f32 v123, v122, v124
    v_cos_f32 v116, v120
    v_cos_f32 v117, v121
    v_cos_f32 v118, v122
    v_cos_f32 v119, v123
    v_sin_f32 v120, v120
    v_sin_f32 v121, v121
    v_sin_f32 v122, v122
    v_sin_f32 v123, v123
    v_cndmask_b32 v116, 0, v116, vcc
    v_cndmask_b32 v120, 0, v120, vcc
    v_cndmask_b32 v117, 0, v117, vcc
    v_cndmask_b32 v121, 0, v121, vcc
    v_cndmask_b32 v118, 0, v118, vcc
    v_cndmask_b32 v122, 0, v122, vcc
    v_cndmask_b32 v119, 0, v119, vcc
    v_cndmask_b32 v123, 0, v123, vcc
    v_cvt_pk_bf16_f32 v126, v116, v120
    v_cvt_pk_bf16_f32 v130, -v120, v116
    v_cvt_pk_bf16_f32 v127, v117, v121
    v_cvt_pk_bf16_f32 v131, -v121, v117
    v_cvt_pk_bf16_f32 v128, v118, v122
    v_cvt_pk_bf16_f32 v132, -v122, v118
    v_cvt_pk_bf16_f32 v129, v119, v123
    v_cvt_pk_bf16_f32 v133, -v123, v119
    s_xor_b32 s54, s80, 3
    s_add_u32 s54, s54, s57
    s_and_b32 s54, s54, 7
    s_lshl_b32 s55, s54, 7
    s_add_u32 s66, s50, s55
    s_mul_i32 s55, s54, s79
    s_waitcnt vmcnt(9)
    s_barrier
    ds_read_b128 v[12:15], v10 offset:0
    ds_read_b128 v[16:19], v10 offset:1024
    ds_read_b128 v[20:23], v10 offset:2048
    ds_read_b128 v[24:27], v10 offset:3072
    ds_read_b128 v[28:31], v10 offset:4096
    ds_read_b128 v[32:35], v10 offset:5120
    ds_read_b128 v[36:39], v10 offset:6144
    ds_read_b128 v[40:43], v10 offset:7168
    ds_read_b128 v[44:47], v10 offset:8192
    ds_read_b128 v[48:51], v10 offset:9216
    ds_read_b128 v[52:55], v10 offset:10240
    ds_read_b128 v[56:59], v10 offset:11264
    s_waitcnt lgkmcnt(8)
    v_add_u32 v25, s87, v25
    s_cmp_eq_u32 s60, 15
    s_cselect_b64 s[82:83], -1, 0
    v_cndmask_b32 v12, v12, v4, s[82:83]
    v_cndmask_b32 v13, v13, v4, s[82:83]
    v_cndmask_b32 v14, v14, v4, s[82:83]
    s_mov_b64 s[82:83], 0xffff
    ds_read_b128 v[60:63], v10 offset:12288
    s_add_u32 m0, s62, 0
    s_nop 0
    buffer_load_dwordx4 v12, s[8:11], s71 offen offset:0 lds
    ds_read_b128 v[64:67], v10 offset:13312
    ds_read_b128 v[68:71], v10 offset:14336
    ds_read_b128 v[72:75], v10 offset:15360
    ds_read_b128 v[76:79], v10 offset:16384
    ds_read_b128 v[80:83], v10 offset:17408
    ds_read_b128 v[84:87], v10 offset:18432
    ds_read_b128 v[88:91], v10 offset:19456
    ds_read_b128 a[240:243], v10 offset:20480
    buffer_load_dwordx4 v13, s[8:11], s71 offen offset:1024 lds
    ds_read_b128 a[244:247], v10 offset:21504
    ds_read_b128 a[248:251], v10 offset:22528
    ds_read_b128 a[252:255], v10 offset:23552
    s_add_u32 s74, s51, s55
    s_xor_b32 s54, s80, 4
    s_add_u32 s54, s54, s57
    s_and_b32 s54, s54, 7
    s_lshl_b32 s55, s54, 7
    buffer_load_dwordx4 v14, s[8:11], s71 offen offset:2048 lds
    s_add_u32 s67, s50, s55
    s_mul_i32 s55, s54, s79
    s_add_u32 s75, s51, s55
    s_xor_b32 s54, s80, 5
    s_add_u32 s54, s54, s57
    s_and_b32 s54, s54, 7
    s_lshl_b32 s55, s54, 7
    s_add_u32 s68, s50, s55
    buffer_load_dwordx4 v[92:95], v15, s[20:23], s81 offen
    s_mul_i32 s55, s54, s79
    s_add_u32 s76, s51, s55
    s_xor_b32 s54, s80, 6
    s_add_u32 s54, s54, s57
    s_and_b32 s54, s54, 7
    s_lshl_b32 s55, s54, 7
    s_add_u32 s69, s50, s55
    s_mul_i32 s55, s54, s79
    buffer_load_dwordx4 v[96:99], v15, s[24:27], s81 offen
    s_add_u32 s77, s51, s55
    s_xor_b32 s54, s80, 7
    s_add_u32 s54, s54, s57
    s_and_b32 s54, s54, 7
    s_lshl_b32 s55, s54, 7
    s_add_u32 s70, s50, s55
    s_mul_i32 s55, s54, s79
    s_add_u32 s78, s51, s55
    s_and_b32 s54, s3, 1
    s_mul_i32 s89, s54, 3
    s_and_b32 s55, s3, 2
    s_add_u32 s89, s89, s55
    s_sub_u32 s90, 1, s55
    v_mov_b32 v103, 0x3f803f80
    v_accvgpr_write_b32 a0, v103
    v_accvgpr_write_b32 a1, v103
    v_accvgpr_write_b32 a2, v103
    v_accvgpr_write_b32 a3, v103
    s_lshl_b32 s54, s3, 10
    s_add_u32 s54, s54, 157184
    v_add_u32 v103, s54, v4
    s_xor_b32 s54, s3, 2
    s_lshl_b32 s54, s54, 10
    s_add_u32 s54, s54, 157184
    v_add_u32 v114, s54, v4
    s_lshl_b32 s54, s57, 14
    s_add_u32 s54, s54, 14680064
    v_and_b32 v117, 248, v0
    v_add_u32 v117, v0, v117
    v_lshl_add_u32 v115, v117, 4, s54
    v_lshlrev_b32 v118, 14, v1
    s_lshr_b32 s54, s47, 1
    s_lshl_b32 s54, s54, 9
    s_add_u32 s54, s54, 14876672
    v_and_b32 v117, 23, v117
    v_lshl_add_u32 v116, v117, 4, s54
    s_and_b32 s54, s53, 248
    s_add_u32 s54, s54, s53
    s_lshl4_add_u32 s50, s54, 14680064
    s_lshl4_add_u32 s51, s59, s60
    s_and_b32 s54, s51, 248
    s_add_u32 s51, s51, s54
    s_lshl4_add_u32 s51, s51, 14876672
    s_cmp_eq_u32 s3, 0
    s_cselect_b32 s50, s50, 32505856
    s_cselect_b32 s51, s51, 32505856
    s_mov_b32 s61, 0
    s_waitcnt vmcnt(11) lgkmcnt(0)
    ds_read_b64_tr_b16 v[120:121], v25 offset:0
    ds_read_b64_tr_b16 v[122:123], v25 offset:512
    ds_read_b64_tr_b16 v[134:135], v25 offset:1024
    ds_read_b64_tr_b16 v[136:137], v25 offset:1536
    v_mov_b32 v5, 1.0
    v_add_u32 v52, s84, v52
    v_add_u32 v53, s84, v53
    v_add_u32 v54, s84, v54
    v_add_u32 v55, s84, v55
    v_add_u32 v60, s85, v60
    v_add_u32 v58, s86, v58
    v_add_u32 v59, s86, v59
    v_add_u32 v57, s86, v57
    v_add_u32 v56, s86, v56
    v_add_u32 v61, s86, v61
    s_waitcnt lgkmcnt(2)
    v_mfma_f32_16x16x32_bf16 v[138:141], v[120:123], v[16:19], 0
    v_readfirstlane_b32 s20, v120
    v_mfma_f32_16x16x32_bf16 v[142:145], v[120:123], v[20:23], 0
    s_lshl_b32 s20, s20, 16
    s_xor_b32 s20, s20, 0x80000000
    s_waitcnt lgkmcnt(0)
    v_mfma_f32_16x16x32_bf16 v[146:149], v[134:137], v[16:19], 0
    v_readfirstlane_b32 s21, v134
    v_mfma_f32_16x16x32_bf16 v[150:153], v[134:137], v[20:23], 0
    s_lshl_b32 s21, s21, 16
    s_xor_b32 s21, s21, 0x80000000
    v_dot2_f32_bf16 v170, v120, v24, s20
    v_dot2_f32_bf16 v171, v120, v5, s20
    v_dot2_f32_bf16 v172, v121, v24, s20
    v_dot2_f32_bf16 v173, v121, v5, s20
    v_dot2_f32_bf16 v174, v122, v24, s20
    v_dot2_f32_bf16 v175, v122, v5, s20
    v_dot2_f32_bf16 v176, v123, v24, s20
    v_dot2_f32_bf16 v177, v123, v5, s20
    v_pk_mul_f32 v[182:183], v[170:171], v[170:171]
    v_pk_add_f32 v[184:185], v[170:171], v[172:173]
    v_pk_fma_f32 v[182:183], v[172:173], v[172:173], v[182:183]
    v_pk_add_f32 v[184:185], v[184:185], v[174:175]
    v_pk_fma_f32 v[182:183], v[174:175], v[174:175], v[182:183]
    v_pk_add_f32 v[184:185], v[184:185], v[176:177]
    v_pk_fma_f32 v[182:183], v[176:177], v[176:177], v[182:183]
    v_add_f32 v178, v184, v185
    v_add_f32 v180, v182, v183
    v_dot2_f32_bf16 v170, v134, v24, s21
    v_dot2_f32_bf16 v171, v134, v5, s21
    v_dot2_f32_bf16 v172, v135, v24, s21
    v_dot2_f32_bf16 v173, v135, v5, s21
    v_dot2_f32_bf16 v174, v136, v24, s21
    v_dot2_f32_bf16 v175, v136, v5, s21
    v_dot2_f32_bf16 v176, v137, v24, s21
    v_dot2_f32_bf16 v177, v137, v5, s21
    v_pk_mul_f32 v[182:183], v[170:171], v[170:171]
    v_pk_add_f32 v[184:185], v[170:171], v[172:173]
    v_pk_fma_f32 v[182:183], v[172:173], v[172:173], v[182:183]
    v_pk_add_f32 v[184:185], v[184:185], v[174:175]
    v_pk_fma_f32 v[182:183], v[174:175], v[174:175], v[182:183]
    v_pk_add_f32 v[184:185], v[184:185], v[176:177]
    v_pk_fma_f32 v[182:183], v[176:177], v[176:177], v[182:183]
    v_add_f32 v179, v184, v185
    v_add_f32 v181, v182, v183
    v_readfirstlane_b32 s40, v138
    v_readfirstlane_b32 s41, v146
    v_permlane32_swap_b32 v178, v179
    v_permlane32_swap_b32 v180, v181
    v_add_f32 v178, v178, v179
    v_add_f32 v180, v180, v181
    v_mul_f32 v170, s40, v26
    v_mul_f32 v172, s41, v26
    v_permlane16_swap_b32 v178, v180
    v_add_f32 v178, v178, v180
    v_pk_add_f32 v[138:139], v[138:139], v[170:171] op_sel_hi:[1,0] neg_lo:[0,1] neg_hi:[0,1]
    v_pk_add_f32 v[140:141], v[140:141], v[170:171] op_sel_hi:[1,0] neg_lo:[0,1] neg_hi:[0,1]
    v_add_f32_dpp v178, v178, v178 row_ror:8 row_mask:0xf bank_mask:0xf
    v_pk_mul_f32 v[182:183], v[142:143], v[32:33]
    v_pk_mul_f32 v[184:185], v[138:139], v[32:33]
    v_pk_fma_f32 v[138:139], v[138:139], v[28:29], v[182:183]
    v_pk_fma_f32 v[142:143], v[142:143], v[28:29], v[184:185] neg_lo:[0,0,1] neg_hi:[0,0,1]
    v_pk_mul_f32 v[182:183], v[144:145], v[34:35]
    v_pk_mul_f32 v[184:185], v[140:141], v[34:35]
    v_pk_fma_f32 v[140:141], v[140:141], v[30:31], v[182:183]
    s_add_u32 m0, s62, 36864
    s_nop 0
    buffer_load_dwordx4 v6, s[32:35], s64 offen offset:0 lds
    v_pk_fma_f32 v[144:145], v[144:145], v[30:31], v[184:185] neg_lo:[0,0,1] neg_hi:[0,0,1]
    v_add_f32_dpp v178, v178, v178 row_ror:4 row_mask:0xf bank_mask:0xf
    v_cvt_pk_bf16_f32 v120, v138, v142
    v_cvt_pk_bf16_f32 v121, v139, v143
    v_cvt_pk_bf16_f32 v122, v140, v144
    v_cvt_pk_bf16_f32 v123, v141, v145
    v_pk_add_f32 v[146:147], v[146:147], v[172:173] op_sel_hi:[1,0] neg_lo:[0,1] neg_hi:[0,1]
    v_pk_add_f32 v[148:149], v[148:149], v[172:173] op_sel_hi:[1,0] neg_lo:[0,1] neg_hi:[0,1]
    v_add_f32_dpp v178, v178, v178 row_ror:2 row_mask:0xf bank_mask:0xf
    v_pk_mul_f32 v[182:183], v[150:151], v[32:33]
    v_pk_mul_f32 v[184:185], v[146:147], v[32:33]
    v_pk_fma_f32 v[146:147], v[146:147], v[28:29], v[182:183]
    buffer_load_dwordx4 v7, s[32:35], s64 offen offset:1024 lds
    v_pk_fma_f32 v[150:151], v[150:151], v[28:29], v[184:185] neg_lo:[0,0,1] neg_hi:[0,0,1]
    v_pk_mul_f32 v[182:183], v[152:153], v[34:35]
    v_pk_mul_f32 v[184:185], v[148:149], v[34:35]
    v_pk_fma_f32 v[148:149], v[148:149], v[30:31], v[182:183]
    v_pk_fma_f32 v[152:153], v[152:153], v[30:31], v[184:185] neg_lo:[0,0,1] neg_hi:[0,0,1]
    v_add_f32_dpp v178, v178, v178 row_ror:1 row_mask:0xf bank_mask:0xf
    v_cvt_pk_bf16_f32 v134, v146, v150
    v_cvt_pk_bf16_f32 v135, v147, v151
    v_cvt_pk_bf16_f32 v136, v148, v152
    v_cvt_pk_bf16_f32 v137, v149, v153
    v_mov_b32 v179, v178
    v_mfma_f32_16x16x32_bf16 v[138:141], v[120:123], v[36:39], 0
    buffer_load_dwordx4 v8, s[32:35], s64 offen offset:2048 lds
    v_permlane16_swap_b32 v178, v179
    v_mul_f32 v178, 0x3b000000, v178
    v_mfma_f32_16x16x32_bf16 v[142:145], v[120:123], v[40:43], 0
    v_mul_f32 v179, 0x3b000000, v179
    v_fma_f32 v179, -v178, v178, v179
    v_mfma_f32_16x16x32_bf16 v[154:157], v[120:123], v[44:47], 0
    v_max_f32 v179, 0, v179
    v_cvt_pk_bf16_f32 v179, v179, v179
    v_mfma_f32_16x16x32_bf16 v[158:161], v[120:123], v[48:51], 0
    v_lshlrev_b32 v179, 16, v179
    v_add_f32 v179, 0x3727c5ac, v179
    v_mfma_f32_16x16x32_bf16 v[146:149], v[134:137], v[36:39], 0
    buffer_load_dwordx4 v9, s[32:35], s64 offen offset:3072 lds
    v_cvt_pk_bf16_f32 v179, v179, v179
    v_lshlrev_b32 v179, 16, v179
    v_mfma_f32_16x16x32_bf16 v[150:153], v[134:137], v[40:43], 0
    v_sqrt_f32 v179, v179
    s_nop 0
    v_cvt_pk_bf16_f32 v179, v179, v179
    v_mfma_f32_16x16x32_bf16 v[162:165], v[134:137], v[44:47], 0
    v_lshlrev_b32 v179, 16, v179
    v_rcp_f32 v179, v179
    v_mfma_f32_16x16x32_bf16 v[166:169], v[134:137], v[48:51], 0
    v_readlane_b32 s36, v179, 0
    v_readlane_b32 s38, v179, 32
    s_nop 0
    v_mul_f32 v170, s36, v27
    s_add_u32 m0, s62, 32768
    s_nop 0
    buffer_load_dwordx4 v12, s[8:11], s72 offen offset:0 lds
    v_mul_f32 v172, s38, v27
    v_cndmask_b32 v138, v138, v154, s[82:83]
    v_cndmask_b32 v142, v142, v158, s[82:83]
    v_pk_mul_f32 v[138:139], v[138:139], s[36:37] op_sel_hi:[1,0]
    v_pk_mul_f32 v[142:143], v[142:143], v[170:171] op_sel_hi:[1,0]
    v_pk_mul_f32 v[140:141], v[140:141], s[36:37] op_sel_hi:[1,0]
    v_pk_mul_f32 v[144:145], v[144:145], v[170:171] op_sel_hi:[1,0]
    v_cvt_pk_bf16_f32 v186, v138, v142
    v_cvt_pk_bf16_f32 v188, v139, v143
    v_cvt_pk_bf16_f32 v190, v140, v144
    v_cvt_pk_bf16_f32 v192, v141, v145
    v_cndmask_b32 v146, v146, v162, s[82:83]
    v_lshlrev_b32 v101, 18, v1
    s_xor_b32 s56, s48, 32768
    s_mov_b64 exec, 3
    buffer_load_dword v101, v101, s[4:7], s56 offen offset:384
    s_mov_b64 exec, -1
    v_cndmask_b32 v150, v150, v166, s[82:83]
    v_pk_mul_f32 v[146:147], v[146:147], s[38:39] op_sel_hi:[1,0]
    v_pk_mul_f32 v[150:151], v[150:151], v[172:173] op_sel_hi:[1,0]
    v_pk_mul_f32 v[148:149], v[148:149], s[38:39] op_sel_hi:[1,0]
    v_pk_mul_f32 v[152:153], v[152:153], v[172:173] op_sel_hi:[1,0]
    v_cvt_pk_bf16_f32 v187, v146, v150
    v_cvt_pk_bf16_f32 v189, v147, v151
    v_cvt_pk_bf16_f32 v191, v148, v152
    v_cvt_pk_bf16_f32 v193, v149, v153
    ds_write_b64 v52, v[186:187]
    ds_write_b64 v53, v[188:189]
    ds_write_b64 v54, v[190:191]
    ds_write_b64 v55, v[192:193]
    s_mov_b32 s54, s89
    s_and_b32 s55, s54, 1
    s_lshl_b32 s55, s55, 5
    v_xor_b32 v104, s55, v64
    s_lshr_b32 s55, s54, 1
    v_lshl_add_u32 v104, s55, 6, v104
    v_add_u32 v107, 65536, v104
    s_add_u32 s54, s54, s90
    s_and_b32 s55, s54, 1
    s_lshl_b32 s55, s55, 5
    v_xor_b32 v105, s55, v64
    s_lshr_b32 s55, s54, 1
    s_waitcnt lgkmcnt(0)
    s_barrier
    ds_read_b128 v[120:123], v60 offset:0
    ds_read_b128 v[134:137], v60 offset:528
    v_lshl_add_u32 v105, s55, 6, v105
    v_add_u32 v108, 65536, v105
    s_add_u32 s54, s54, s90
    s_and_b32 s55, s54, 1
    s_lshl_b32 s55, s55, 5
    v_xor_b32 v106, s55, v64
    s_lshr_b32 s55, s54, 1
    v_lshl_add_u32 v106, s55, 6, v106
    v_add_u32 v109, 65536, v106
    s_add_u32 s54, s54, s90
    s_and_b32 s54, s62, 16384
    v_add_u32 v110, s54, v65
    v_xor_b32 v111, 64, v110
    v_add_u32 v112, 65536, v110
    v_add_u32 v113, 65536, v111
    v_sub_f32 v180, s20, v178
    v_sub_f32 v181, s21, v178
    v_cvt_pk_bf16_f32 v180, v180, v181
    v_lshlrev_b32 v181, 16, v180
    v_and_b32 v180, 0xffff0000, v180
    buffer_load_dwordx4 v13, s[8:11], s72 offen offset:1024 lds
    s_lshl_b32 s54, s53, 8
    s_lshl2_add_u32 s0, s3, s54
    s_mov_b64 exec, 2
    v_mov_b32 v179, v181
    s_mov_b32 exec_lo, 0
    s_mov_b32 exec_hi, 2
    v_mov_b32 v179, v180
    s_mov_b64 exec, -1
    buffer_load_dwordx4 v14, s[8:11], s72 offen offset:2048 lds
    s_waitcnt lgkmcnt(1)
    v_mfma_f32_16x16x32_bf16 v[138:141], v[120:123], v[126:129], 0
    v_mfma_f32_16x16x32_bf16 v[142:145], v[120:123], v[130:133], 0
    s_add_u32 m0, s62, 69632
    s_nop 0
    buffer_load_dwordx4 v6, s[32:35], s65 offen offset:0 lds
    s_waitcnt lgkmcnt(0)
    v_mfma_f32_16x16x32_bf16 v[146:149], v[134:137], v[126:129], 0
    v_mfma_f32_16x16x32_bf16 v[150:153], v[134:137], v[130:133], 0
    s_nop 1
    v_cvt_pk_bf16_f32 v120, v138, v142
    v_cvt_pk_bf16_f32 v121, v139, v143
    v_cvt_pk_bf16_f32 v122, v140, v144
    v_cvt_pk_bf16_f32 v123, v141, v145
    ds_write_b128 v58, v[120:123]
    s_nop 0
    v_cvt_pk_bf16_f32 v134, v146, v150
    v_cvt_pk_bf16_f32 v135, v147, v151
    v_cvt_pk_bf16_f32 v136, v148, v152
    v_cvt_pk_bf16_f32 v137, v149, v153
    ds_write_b128 v59, v[134:137]
    s_waitcnt vmcnt(14)
    buffer_load_dwordx4 v7, s[32:35], s65 offen offset:1024 lds
    v_readfirstlane_b32 s79, v11
    s_mul_i32 s79, s79, 1664525
    s_add_u32 s79, s79, 1013904223
    v_mov_b32 v11, s79
    s_mul_i32 s54, s58, 43
    s_mul_i32 s55, s3, 11
    s_add_u32 s54, s54, s55
    v_min_u32 v10, 10, v2
    v_add_lshl_u32 v10, s54, v10, 10
    s_lshl_b32 s22, s3, 9
    s_add_u32 s22, s22, s57
    s_lshl_b32 s22, s22, 11
    buffer_load_dwordx4 v8, s[32:35], s65 offen offset:2048 lds
    s_lshl_b32 s54, s58, 6
    v_xor_b32 v67, s54, v67
    s_lshr_b32 s54, s3, 1
    s_lshl1_add_u32 s54, s59, s54
    s_lshl_b32 s1, s54, 11
    s_mul_i32 s54, s54, 176128
    s_add_u32 s54, s54, 6291456
    s_mul_i32 s55, s60, 6
    s_add_u32 s55, s55, s89
    s_lshl_b32 s25, s55, 11
    s_add_u32 s25, s25, s54
    s_cmp_lt_u32 s55, 86
    s_cselect_b32 s25, s25, 32505856
    buffer_load_dwordx4 v9, s[32:35], s65 offen offset:3072 lds
    s_add_u32 s55, s55, s90
    s_lshl_b32 s26, s55, 11
    s_add_u32 s26, s26, s54
    s_cmp_lt_u32 s55, 86
    s_cselect_b32 s26, s26, 32505856
    s_add_u32 s55, s55, s90
    s_lshl_b32 s27, s55, 11
    s_add_u32 s27, s27, s54
    s_cmp_lt_u32 s55, 86
    s_cselect_b32 s27, s27, 32505856
    v_add_u32 v162, 7168, v72
    s_add_u32 m0, s62, 65536
    s_nop 0
    buffer_load_dwordx4 v12, s[8:11], s73 offen offset:0 lds
    v_add_u32 v163, 14336, v72
    v_add_u32 v164, 21504, v72
    s_mul_i32 s24, s3, 360448
    s_lshl_b32 s54, s52, 7
    s_add_u32 s24, s24, s54
    s_lshl_b32 s36, s57, 12
    s_add_u32 s37, s36, 4096
    s_add_u32 s38, s37, 4096
    s_add_u32 s39, s38, 4096
    s_add_u32 s40, s39, 4096
    s_cmp_eq_u32 s40, 45056
    s_cselect_b32 s40, 0, s40
    buffer_load_dwordx4 v13, s[8:11], s73 offen offset:1024 lds
    s_add_u32 s41, s40, 4096
    s_cmp_eq_u32 s41, 45056
    s_cselect_b32 s41, 0, s41
    s_add_u32 s42, s41, 4096
    s_cmp_eq_u32 s42, 45056
    s_cselect_b32 s42, 0, s42
    s_add_u32 s43, s42, 4096
    s_cmp_eq_u32 s43, 45056
    s_cselect_b32 s43, 0, s43
    s_add_u32 s44, s43, 4096
    s_cmp_eq_u32 s44, 45056
    s_cselect_b32 s44, 0, s44
    buffer_load_dwordx4 v14, s[8:11], s73 offen offset:2048 lds
    s_add_u32 s45, s44, 4096
    s_cmp_eq_u32 s45, 45056
    s_cselect_b32 s45, 0, s45
    s_add_u32 s46, s45, 4096
    s_cmp_eq_u32 s46, 45056
    s_cselect_b32 s46, 0, s46
    s_add_u32 s54, s87, 131072
    v_add_u32 v5, s54, v4
    s_lshl_b32 s23, s2, 13
    s_add_u32 s23, s23, s87
    s_add_u32 s23, s23, 4194304
    s_lshl_b32 s54, s3, 3
    s_lshl2_add_u32 s55, s3, 32
    v_xor_b32 v124, s55, v68
    v_xor_b32 v68, s54, v68
    v_xor_b32 v69, s54, v69
    v_xor_b32 v125, 16, v124
    v_xor_b32 v154, 0x80000000, v36
    v_xor_b32 v158, 0x8000, v40
    v_xor_b32 v155, 0x80000000, v37
    v_xor_b32 v159, 0x8000, v41
    v_xor_b32 v156, 0x80000000, v38
    v_xor_b32 v160, 0x8000, v42
    v_xor_b32 v157, 0x80000000, v39
    v_xor_b32 v161, 0x8000, v43
    s_waitcnt vmcnt(15)
    ds_write_b128 v57, v[92:95]
    ds_write_b128 v56, v[96:99]
    ds_read_b128 v[138:141], v61 offset:0
    ds_read_b128 v[142:145], v61 offset:1088
    ds_read_b128 v[146:149], v61 offset:2176
    ds_read_b128 v[150:153], v61 offset:3264
    s_mov_b32 exec_lo, 3
    s_mov_b32 exec_hi, 3
    buffer_store_dword v179, v63, s[16:19], s0 offen sc1
    s_mov_b64 exec, -1
    s_waitcnt lgkmcnt(3)
    buffer_store_dwordx4 v[138:141], v62, s[16:19], s88 offen sc1
    s_waitcnt lgkmcnt(2)
    s_add_u32 s88, s88, 4096
    buffer_store_dwordx4 v[142:145], v62, s[16:19], s88 offen sc1
    s_waitcnt lgkmcnt(1)
    s_add_u32 s88, s88, 4096
    buffer_store_dwordx4 v[146:149], v62, s[16:19], s88 offen sc1
    s_waitcnt lgkmcnt(0)
    s_add_u32 s88, s88, 4096
    buffer_store_dwordx4 v[150:153], v62, s[16:19], s88 offen sc1
    s_waitcnt vmcnt(22)
    s_barrier
    ds_read_b64_tr_b16 a[36:37], v104 offset:0
    ds_read_b64_tr_b16 a[38:39], v104 offset:8192
    ds_read_b128 a[4:7], v110 offset:0
    ds_read_b128 a[8:11], v110 offset:2048
    ds_read_b128 a[12:15], v110 offset:8192
    ds_read_b128 a[16:19], v110 offset:10240
    ds_read_b64_tr_b16 a[40:41], v105 offset:0
    ds_read_b64_tr_b16 a[42:43], v105 offset:8192
    ds_read_b64_tr_b16 a[44:45], v106 offset:0
    ds_read_b64_tr_b16 a[46:47], v106 offset:8192
    s_waitcnt lgkmcnt(0)
    v_mfma_f32_16x16x32_bf16 v[16:19], a[36:39], a[0:3], 0
    ds_read_b64_tr_b16 a[48:49], v104 offset:16384
    v_mfma_f32_16x16x32_bf16 v[182:185], a[36:39], a[4:7], 0
    ds_read_b64_tr_b16 a[50:51], v104 offset:24576
    v_mfma_f32_16x16x32_bf16 v[186:189], a[36:39], a[8:11], 0
    s_add_u32 m0, s62, 102400
    s_nop 0
    buffer_load_dwordx4 v6, s[32:35], s66 offen offset:0 lds
    v_mfma_f32_16x16x32_bf16 v[190:193], a[36:39], a[12:15], 0
    ds_read_b128 a[20:23], v111 offset:0
    v_mfma_f32_16x16x32_bf16 v[194:197], a[36:39], a[16:19], 0
    ds_read_b128 a[24:27], v111 offset:2048
    v_mfma_f32_16x16x32_bf16 v[20:23], a[40:43], a[0:3], 0
    buffer_load_dwordx4 v7, s[32:35], s66 offen offset:1024 lds
    v_mfma_f32_16x16x32_bf16 v[198:201], a[40:43], a[4:7], 0
    ds_read_b128 a[28:31], v111 offset:8192
    v_mfma_f32_16x16x32_bf16 v[202:205], a[40:43], a[8:11], 0
    ds_read_b128 a[32:35], v111 offset:10240
    v_mfma_f32_16x16x32_bf16 v[206:209], a[40:43], a[12:15], 0
    buffer_load_dwordx4 v8, s[32:35], s66 offen offset:2048 lds
    v_mfma_f32_16x16x32_bf16 v[210:213], a[40:43], a[16:19], 0
    ds_read_b64_tr_b16 a[52:53], v105 offset:16384
    v_mfma_f32_16x16x32_bf16 v[214:217], a[44:47], a[4:7], 0
    ds_read_b64_tr_b16 a[54:55], v105 offset:24576
    v_mfma_f32_16x16x32_bf16 v[218:221], a[44:47], a[8:11], 0
    buffer_load_dwordx4 v9, s[32:35], s66 offen offset:3072 lds
    v_mfma_f32_16x16x32_bf16 v[222:225], a[44:47], a[12:15], 0
    ds_read_b64_tr_b16 a[56:57], v106 offset:16384
    v_mfma_f32_16x16x32_bf16 v[226:229], a[44:47], a[16:19], 0
    ds_read_b64_tr_b16 a[58:59], v106 offset:24576
    s_waitcnt vmcnt(16) lgkmcnt(0)
    s_barrier
    v_mfma_f32_16x16x32_bf16 v[16:19], a[48:51], a[0:3], v[16:19]
    ds_read_b64_tr_b16 a[36:37], v104 offset:32768
    v_mfma_f32_16x16x32_bf16 v[182:185], a[48:51], a[20:23], v[182:185]
    ds_read_b64_tr_b16 a[38:39], v104 offset:40960
    v_mfma_f32_16x16x32_bf16 v[186:189], a[48:51], a[24:27], v[186:189]
    s_add_u32 m0, s62, 98304
    s_nop 0
    buffer_load_dwordx4 v12, s[8:11], s74 offen offset:0 lds
    v_mfma_f32_16x16x32_bf16 v[190:193], a[48:51], a[28:31], v[190:193]
    ds_read_b128 a[4:7], v110 offset:32768
    v_mfma_f32_16x16x32_bf16 v[194:197], a[48:51], a[32:35], v[194:197]
    ds_read_b128 a[8:11], v110 offset:34816
    v_mfma_f32_16x16x32_bf16 v[20:23], a[52:55], a[0:3], v[20:23]
    buffer_load_dwordx4 v13, s[8:11], s74 offen offset:1024 lds
    v_mfma_f32_16x16x32_bf16 v[198:201], a[52:55], a[20:23], v[198:201]
    ds_read_b128 a[12:15], v110 offset:40960
    v_mfma_f32_16x16x32_bf16 v[202:205], a[52:55], a[24:27], v[202:205]
    ds_read_b128 a[16:19], v110 offset:43008
    v_mfma_f32_16x16x32_bf16 v[206:209], a[52:55], a[28:31], v[206:209]
    buffer_load_dwordx4 v14, s[8:11], s74 offen offset:2048 lds
    v_mfma_f32_16x16x32_bf16 v[210:213], a[52:55], a[32:35], v[210:213]
    ds_read_b64_tr_b16 a[40:41], v105 offset:32768
    v_mfma_f32_16x16x32_bf16 v[214:217], a[56:59], a[20:23], v[214:217]
    ds_read_b64_tr_b16 a[42:43], v105 offset:40960
    v_mfma_f32_16x16x32_bf16 v[218:221], a[56:59], a[24:27], v[218:221]
    ds_read_b64_tr_b16 a[44:45], v106 offset:32768
    v_mfma_f32_16x16x32_bf16 v[222:225], a[56:59], a[28:31], v[222:225]
    ds_read_b64_tr_b16 a[46:47], v106 offset:40960
    v_mfma_f32_16x16x32_bf16 v[226:229], a[56:59], a[32:35], v[226:229]
    s_waitcnt lgkmcnt(0)
    v_mfma_f32_16x16x32_bf16 v[16:19], a[36:39], a[0:3], v[16:19]
    ds_read_b64_tr_b16 a[48:49], v104 offset:49152
    v_mfma_f32_16x16x32_bf16 v[182:185], a[36:39], a[4:7], v[182:185]
    ds_read_b64_tr_b16 a[50:51], v104 offset:57344
    v_mfma_f32_16x16x32_bf16 v[186:189], a[36:39], a[8:11], v[186:189]
    s_add_u32 m0, s62, 4096
    s_nop 0
    buffer_load_dwordx4 v6, s[32:35], s67 offen offset:0 lds
    v_mfma_f32_16x16x32_bf16 v[190:193], a[36:39], a[12:15], v[190:193]
    ds_read_b128 a[20:23], v111 offset:32768
    v_mfma_f32_16x16x32_bf16 v[194:197], a[36:39], a[16:19], v[194:197]
    ds_read_b128 a[24:27], v111 offset:34816
    v_mfma_f32_16x16x32_bf16 v[20:23], a[40:43], a[0:3], v[20:23]
    buffer_load_dwordx4 v7, s[32:35], s67 offen offset:1024 lds
    v_mfma_f32_16x16x32_bf16 v[198:201], a[40:43], a[4:7], v[198:201]
    ds_read_b128 a[28:31], v111 offset:40960
    v_mfma_f32_16x16x32_bf16 v[202:205], a[40:43], a[8:11], v[202:205]
    ds_read_b128 a[32:35], v111 offset:43008
    v_mfma_f32_16x16x32_bf16 v[206:209], a[40:43], a[12:15], v[206:209]
    buffer_load_dwordx4 v8, s[32:35], s67 offen offset:2048 lds
    v_mfma_f32_16x16x32_bf16 v[210:213], a[40:43], a[16:19], v[210:213]
    ds_read_b64_tr_b16 a[52:53], v105 offset:49152
    v_mfma_f32_16x16x32_bf16 v[214:217], a[44:47], a[4:7], v[214:217]
    ds_read_b64_tr_b16 a[54:55], v105 offset:57344
    v_mfma_f32_16x16x32_bf16 v[218:221], a[44:47], a[8:11], v[218:221]
    buffer_load_dwordx4 v9, s[32:35], s67 offen offset:3072 lds
    v_mfma_f32_16x16x32_bf16 v[222:225], a[44:47], a[12:15], v[222:225]
    ds_read_b64_tr_b16 a[56:57], v106 offset:49152
    v_mfma_f32_16x16x32_bf16 v[226:229], a[44:47], a[16:19], v[226:229]
    ds_read_b64_tr_b16 a[58:59], v106 offset:57344
    s_waitcnt vmcnt(11) lgkmcnt(0)
    s_barrier
    v_mfma_f32_16x16x32_bf16 v[16:19], a[48:51], a[0:3], v[16:19]
    ds_read_b64_tr_b16 a[36:37], v107 offset:0
    v_mfma_f32_16x16x32_bf16 v[182:185], a[48:51], a[20:23], v[182:185]
    ds_read_b64_tr_b16 a[38:39], v107 offset:8192
    v_mfma_f32_16x16x32_bf16 v[186:189], a[48:51], a[24:27], v[186:189]
    s_mov_b64 exec, 255
    buffer_store_dword v11, v118, s[16:19], s50 offen sc1
    s_mov_b64 exec, -1
    v_mfma_f32_16x16x32_bf16 v[190:193], a[48:51], a[28:31], v[190:193]
    ds_read_b128 a[4:7], v112 offset:0
    v_mfma_f32_16x16x32_bf16 v[194:197], a[48:51], a[32:35], v[194:197]
    ds_read_b128 a[8:11], v112 offset:2048
    v_mfma_f32_16x16x32_bf16 v[20:23], a[52:55], a[0:3], v[20:23]
    s_add_u32 m0, s62, 0
    s_nop 0
    buffer_load_dwordx4 v12, s[8:11], s75 offen offset:0 lds
    v_mfma_f32_16x16x32_bf16 v[198:201], a[52:55], a[20:23], v[198:201]
    ds_read_b128 a[12:15], v112 offset:8192
    v_mfma_f32_16x16x32_bf16 v[202:205], a[52:55], a[24:27], v[202:205]
    ds_read_b128 a[16:19], v112 offset:10240
    v_mfma_f32_16x16x32_bf16 v[206:209], a[52:55], a[28:31], v[206:209]
    buffer_load_dwordx4 v13, s[8:11], s75 offen offset:1024 lds
    v_mfma_f32_16x16x32_bf16 v[210:213], a[52:55], a[32:35], v[210:213]
    ds_read_b64_tr_b16 a[40:41], v108 offset:0
    v_mfma_f32_16x16x32_bf16 v[214:217], a[56:59], a[20:23], v[214:217]
    ds_read_b64_tr_b16 a[42:43], v108 offset:8192
    v_mfma_f32_16x16x32_bf16 v[218:221], a[56:59], a[24:27], v[218:221]
    buffer_load_dwordx4 v14, s[8:11], s75 offen offset:2048 lds
    v_mfma_f32_16x16x32_bf16 v[222:225], a[56:59], a[28:31], v[222:225]
    ds_read_b64_tr_b16 a[44:45], v109 offset:0
    v_mfma_f32_16x16x32_bf16 v[226:229], a[56:59], a[32:35], v[226:229]
    ds_read_b64_tr_b16 a[46:47], v109 offset:8192
    s_waitcnt lgkmcnt(0)
    v_mfma_f32_16x16x32_bf16 v[16:19], a[36:39], a[0:3], v[16:19]
    ds_read_b64_tr_b16 a[48:49], v107 offset:16384
    v_mfma_f32_16x16x32_bf16 v[182:185], a[36:39], a[4:7], v[182:185]
    ds_read_b64_tr_b16 a[50:51], v107 offset:24576
    v_mfma_f32_16x16x32_bf16 v[186:189], a[36:39], a[8:11], v[186:189]
    s_add_u32 m0, s62, 36864
    s_nop 0
    buffer_load_dwordx4 v6, s[32:35], s68 offen offset:0 lds
    v_mfma_f32_16x16x32_bf16 v[190:193], a[36:39], a[12:15], v[190:193]
    ds_read_b128 a[20:23], v113 offset:0
    v_mfma_f32_16x16x32_bf16 v[194:197], a[36:39], a[16:19], v[194:197]
    ds_read_b128 a[24:27], v113 offset:2048
    v_mfma_f32_16x16x32_bf16 v[20:23], a[40:43], a[0:3], v[20:23]
    buffer_load_dwordx4 v7, s[32:35], s68 offen offset:1024 lds
    v_mfma_f32_16x16x32_bf16 v[198:201], a[40:43], a[4:7], v[198:201]
    ds_read_b128 a[28:31], v113 offset:8192
    v_mfma_f32_16x16x32_bf16 v[202:205], a[40:43], a[8:11], v[202:205]
    ds_read_b128 a[32:35], v113 offset:10240
    v_mfma_f32_16x16x32_bf16 v[206:209], a[40:43], a[12:15], v[206:209]
    buffer_load_dwordx4 v8, s[32:35], s68 offen offset:2048 lds
    v_mfma_f32_16x16x32_bf16 v[210:213], a[40:43], a[16:19], v[210:213]
    ds_read_b64_tr_b16 a[52:53], v108 offset:16384
    v_mfma_f32_16x16x32_bf16 v[214:217], a[44:47], a[4:7], v[214:217]
    ds_read_b64_tr_b16 a[54:55], v108 offset:24576
    v_mfma_f32_16x16x32_bf16 v[218:221], a[44:47], a[8:11], v[218:221]
    buffer_load_dwordx4 v9, s[32:35], s68 offen offset:3072 lds
    v_mfma_f32_16x16x32_bf16 v[222:225], a[44:47], a[12:15], v[222:225]
    ds_read_b64_tr_b16 a[56:57], v109 offset:16384
    v_mfma_f32_16x16x32_bf16 v[226:229], a[44:47], a[16:19], v[226:229]
    ds_read_b64_tr_b16 a[58:59], v109 offset:24576
    s_waitcnt vmcnt(12) lgkmcnt(0)
    s_barrier
    v_mfma_f32_16x16x32_bf16 v[16:19], a[48:51], a[0:3], v[16:19]
    ds_read_b64_tr_b16 a[36:37], v107 offset:32768
    v_mfma_f32_16x16x32_bf16 v[182:185], a[48:51], a[20:23], v[182:185]
    ds_read_b64_tr_b16 a[38:39], v107 offset:40960
    v_mfma_f32_16x16x32_bf16 v[186:189], a[48:51], a[24:27], v[186:189]
    s_add_u32 m0, s62, 32768
    s_nop 0
    buffer_load_dwordx4 v12, s[8:11], s76 offen offset:0 lds
    v_mfma_f32_16x16x32_bf16 v[190:193], a[48:51], a[28:31], v[190:193]
    ds_read_b128 a[4:7], v112 offset:32768
    v_mfma_f32_16x16x32_bf16 v[194:197], a[48:51], a[32:35], v[194:197]
    ds_read_b128 a[8:11], v112 offset:34816
    v_mfma_f32_16x16x32_bf16 v[20:23], a[52:55], a[0:3], v[20:23]
    buffer_load_dwordx4 v13, s[8:11], s76 offen offset:1024 lds
    v_mfma_f32_16x16x32_bf16 v[198:201], a[52:55], a[20:23], v[198:201]
    ds_read_b128 a[12:15], v112 offset:40960
    v_mfma_f32_16x16x32_bf16 v[202:205], a[52:55], a[24:27], v[202:205]
    ds_read_b128 a[16:19], v112 offset:43008
    v_mfma_f32_16x16x32_bf16 v[206:209], a[52:55], a[28:31], v[206:209]
    buffer_load_dwordx4 v14, s[8:11], s76 offen offset:2048 lds
    v_mfma_f32_16x16x32_bf16 v[210:213], a[52:55], a[32:35], v[210:213]
    ds_read_b64_tr_b16 a[40:41], v108 offset:32768
    v_mfma_f32_16x16x32_bf16 v[214:217], a[56:59], a[20:23], v[214:217]
    ds_read_b64_tr_b16 a[42:43], v108 offset:40960
    v_mfma_f32_16x16x32_bf16 v[218:221], a[56:59], a[24:27], v[218:221]
    ds_read_b64_tr_b16 a[44:45], v109 offset:32768
    v_mfma_f32_16x16x32_bf16 v[222:225], a[56:59], a[28:31], v[222:225]
    ds_read_b64_tr_b16 a[46:47], v109 offset:40960
    v_mfma_f32_16x16x32_bf16 v[226:229], a[56:59], a[32:35], v[226:229]
    s_waitcnt lgkmcnt(0)
    v_mfma_f32_16x16x32_bf16 v[16:19], a[36:39], a[0:3], v[16:19]
    ds_read_b64_tr_b16 a[48:49], v107 offset:49152
    ds_read_b64_tr_b16 a[50:51], v107 offset:57344
    v_mfma_f32_16x16x32_bf16 v[182:185], a[36:39], a[4:7], v[182:185]
    s_add_u32 m0, s62, 69632
    s_nop 0
    buffer_load_dwordx4 v6, s[32:35], s69 offen offset:0 lds
    v_mfma_f32_16x16x32_bf16 v[186:189], a[36:39], a[8:11], v[186:189]
    ds_read_b128 a[20:23], v113 offset:32768
    v_mfma_f32_16x16x32_bf16 v[190:193], a[36:39], a[12:15], v[190:193]
    ds_read_b128 a[24:27], v113 offset:34816
    v_mfma_f32_16x16x32_bf16 v[194:197], a[36:39], a[16:19], v[194:197]
    buffer_load_dwordx4 v7, s[32:35], s69 offen offset:1024 lds
    v_mfma_f32_16x16x32_bf16 v[20:23], a[40:43], a[0:3], v[20:23]
    ds_read_b128 a[28:31], v113 offset:40960
    v_mfma_f32_16x16x32_bf16 v[198:201], a[40:43], a[4:7], v[198:201]
    ds_read_b128 a[32:35], v113 offset:43008
    v_mfma_f32_16x16x32_bf16 v[202:205], a[40:43], a[8:11], v[202:205]
    buffer_load_dwordx4 v8, s[32:35], s69 offen offset:2048 lds
    v_mfma_f32_16x16x32_bf16 v[206:209], a[40:43], a[12:15], v[206:209]
    ds_read_b64_tr_b16 a[52:53], v108 offset:49152
    v_mfma_f32_16x16x32_bf16 v[210:213], a[40:43], a[16:19], v[210:213]
    ds_read_b64_tr_b16 a[54:55], v108 offset:57344
    v_mfma_f32_16x16x32_bf16 v[214:217], a[44:47], a[4:7], v[214:217]
    buffer_load_dwordx4 v9, s[32:35], s69 offen offset:3072 lds
    v_mfma_f32_16x16x32_bf16 v[218:221], a[44:47], a[8:11], v[218:221]
    ds_read_b64_tr_b16 a[56:57], v109 offset:49152
    v_mfma_f32_16x16x32_bf16 v[222:225], a[44:47], a[12:15], v[222:225]
    ds_read_b64_tr_b16 a[58:59], v109 offset:57344
    v_mfma_f32_16x16x32_bf16 v[226:229], a[44:47], a[16:19], v[226:229]
    s_mov_b64 exec, 0xffff
    buffer_load_dword v119, v10, s[12:15], 0 offen offset:384
    s_mov_b64 exec, -1
    s_waitcnt vmcnt(12) lgkmcnt(0)
    s_barrier
    v_mfma_f32_16x16x32_bf16 v[16:19], a[48:51], a[0:3], v[16:19]
    ds_read_b64_tr_b16 a[36:37], v104 offset:0
    v_mfma_f32_16x16x32_bf16 v[182:185], a[48:51], a[20:23], v[182:185]
    ds_read_b64_tr_b16 a[38:39], v104 offset:8192
    v_mfma_f32_16x16x32_bf16 v[186:189], a[48:51], a[24:27], v[186:189]
    s_add_u32 m0, s62, 65536
    s_nop 0
    buffer_load_dwordx4 v12, s[8:11], s77 offen offset:0 lds
    v_mfma_f32_16x16x32_bf16 v[190:193], a[48:51], a[28:31], v[190:193]
    ds_read_b128 a[4:7], v110 offset:0
    v_mfma_f32_16x16x32_bf16 v[194:197], a[48:51], a[32:35], v[194:197]
    ds_read_b128 a[8:11], v110 offset:2048
    v_mfma_f32_16x16x32_bf16 v[20:23], a[52:55], a[0:3], v[20:23]
    buffer_load_dwordx4 v13, s[8:11], s77 offen offset:1024 lds
    v_mfma_f32_16x16x32_bf16 v[198:201], a[52:55], a[20:23], v[198:201]
    ds_read_b128 a[12:15], v110 offset:8192
    v_mfma_f32_16x16x32_bf16 v[202:205], a[52:55], a[24:27], v[202:205]
    ds_read_b128 a[16:19], v110 offset:10240
    v_mfma_f32_16x16x32_bf16 v[206:209], a[52:55], a[28:31], v[206:209]
    buffer_load_dwordx4 v14, s[8:11], s77 offen offset:2048 lds
    v_mfma_f32_16x16x32_bf16 v[210:213], a[52:55], a[32:35], v[210:213]
    ds_read_b64_tr_b16 a[40:41], v105 offset:0
    v_mfma_f32_16x16x32_bf16 v[214:217], a[56:59], a[20:23], v[214:217]
    ds_read_b64_tr_b16 a[42:43], v105 offset:8192
    v_mfma_f32_16x16x32_bf16 v[218:221], a[56:59], a[24:27], v[218:221]
    ds_read_b64_tr_b16 a[44:45], v106 offset:0
    v_mfma_f32_16x16x32_bf16 v[222:225], a[56:59], a[28:31], v[222:225]
    ds_read_b64_tr_b16 a[46:47], v106 offset:8192
    v_mfma_f32_16x16x32_bf16 v[226:229], a[56:59], a[32:35], v[226:229]
    s_waitcnt lgkmcnt(0)
    v_mfma_f32_16x16x32_bf16 v[16:19], a[36:39], a[0:3], v[16:19]
    ds_read_b64_tr_b16 a[48:49], v104 offset:16384
    v_mfma_f32_16x16x32_bf16 v[182:185], a[36:39], a[4:7], v[182:185]
    ds_read_b64_tr_b16 a[50:51], v104 offset:24576
    v_mfma_f32_16x16x32_bf16 v[186:189], a[36:39], a[8:11], v[186:189]
    s_add_u32 m0, s62, 102400
    s_nop 0
    buffer_load_dwordx4 v6, s[32:35], s70 offen offset:0 lds
    v_mfma_f32_16x16x32_bf16 v[190:193], a[36:39], a[12:15], v[190:193]
    ds_read_b128 a[20:23], v111 offset:0
    v_mfma_f32_16x16x32_bf16 v[194:197], a[36:39], a[16:19], v[194:197]
    ds_read_b128 a[24:27], v111 offset:2048
    v_mfma_f32_16x16x32_bf16 v[20:23], a[40:43], a[0:3], v[20:23]
    buffer_load_dwordx4 v7, s[32:35], s70 offen offset:1024 lds
    v_mfma_f32_16x16x32_bf16 v[198:201], a[40:43], a[4:7], v[198:201]
    ds_read_b128 a[28:31], v111 offset:8192
    v_mfma_f32_16x16x32_bf16 v[202:205], a[40:43], a[8:11], v[202:205]
    ds_read_b128 a[32:35], v111 offset:10240
    v_mfma_f32_16x16x32_bf16 v[206:209], a[40:43], a[12:15], v[206:209]
    buffer_load_dwordx4 v8, s[32:35], s70 offen offset:2048 lds
    v_mfma_f32_16x16x32_bf16 v[210:213], a[40:43], a[16:19], v[210:213]
    ds_read_b64_tr_b16 a[52:53], v105 offset:16384
    v_mfma_f32_16x16x32_bf16 v[214:217], a[44:47], a[4:7], v[214:217]
    ds_read_b64_tr_b16 a[54:55], v105 offset:24576
    v_mfma_f32_16x16x32_bf16 v[218:221], a[44:47], a[8:11], v[218:221]
    buffer_load_dwordx4 v9, s[32:35], s70 offen offset:3072 lds
    v_mfma_f32_16x16x32_bf16 v[222:225], a[44:47], a[12:15], v[222:225]
    ds_read_b64_tr_b16 a[56:57], v106 offset:16384
    v_mfma_f32_16x16x32_bf16 v[226:229], a[44:47], a[16:19], v[226:229]
    ds_read_b64_tr_b16 a[58:59], v106 offset:24576
    s_waitcnt vmcnt(12) lgkmcnt(0)
    s_barrier
    v_mfma_f32_16x16x32_bf16 v[16:19], a[48:51], a[0:3], v[16:19]
    ds_read_b64_tr_b16 a[36:37], v104 offset:32768
    v_mfma_f32_16x16x32_bf16 v[182:185], a[48:51], a[20:23], v[182:185]
    ds_read_b64_tr_b16 a[38:39], v104 offset:40960
    v_mfma_f32_16x16x32_bf16 v[186:189], a[48:51], a[24:27], v[186:189]
    s_add_u32 m0, s62, 98304
    s_nop 0
    buffer_load_dwordx4 v12, s[8:11], s78 offen offset:0 lds
    v_mfma_f32_16x16x32_bf16 v[190:193], a[48:51], a[28:31], v[190:193]
    ds_read_b128 a[4:7], v110 offset:32768
    v_mfma_f32_16x16x32_bf16 v[194:197], a[48:51], a[32:35], v[194:197]
    ds_read_b128 a[8:11], v110 offset:34816
    v_mfma_f32_16x16x32_bf16 v[20:23], a[52:55], a[0:3], v[20:23]
    buffer_load_dwordx4 v13, s[8:11], s78 offen offset:1024 lds
    v_mfma_f32_16x16x32_bf16 v[198:201], a[52:55], a[20:23], v[198:201]
    ds_read_b128 a[12:15], v110 offset:40960
    v_mfma_f32_16x16x32_bf16 v[202:205], a[52:55], a[24:27], v[202:205]
    ds_read_b128 a[16:19], v110 offset:43008
    v_mfma_f32_16x16x32_bf16 v[206:209], a[52:55], a[28:31], v[206:209]
    buffer_load_dwordx4 v14, s[8:11], s78 offen offset:2048 lds
    v_mfma_f32_16x16x32_bf16 v[210:213], a[52:55], a[32:35], v[210:213]
    ds_read_b64_tr_b16 a[40:41], v105 offset:32768
    v_mfma_f32_16x16x32_bf16 v[214:217], a[56:59], a[20:23], v[214:217]
    ds_read_b64_tr_b16 a[42:43], v105 offset:40960
    v_mfma_f32_16x16x32_bf16 v[218:221], a[56:59], a[24:27], v[218:221]
    ds_read_b64_tr_b16 a[44:45], v106 offset:32768
    v_mfma_f32_16x16x32_bf16 v[222:225], a[56:59], a[28:31], v[222:225]
    ds_read_b64_tr_b16 a[46:47], v106 offset:40960
    v_mfma_f32_16x16x32_bf16 v[226:229], a[56:59], a[32:35], v[226:229]
    s_waitcnt lgkmcnt(0)
    v_mfma_f32_16x16x32_bf16 v[16:19], a[36:39], a[0:3], v[16:19]
    ds_read_b64_tr_b16 a[48:49], v104 offset:49152
    ds_read_b64_tr_b16 a[50:51], v104 offset:57344
    v_mfma_f32_16x16x32_bf16 v[182:185], a[36:39], a[4:7], v[182:185]
    buffer_load_dword v117, v115, s[16:19], 0 offen sc1
    v_mfma_f32_16x16x32_bf16 v[186:189], a[36:39], a[8:11], v[186:189]
    ds_read_b128 a[20:23], v111 offset:32768
    v_mfma_f32_16x16x32_bf16 v[190:193], a[36:39], a[12:15], v[190:193]
    ds_read_b128 a[24:27], v111 offset:34816
    v_mfma_f32_16x16x32_bf16 v[194:197], a[36:39], a[16:19], v[194:197]
    s_add_u32 m0, s62, 0
    s_lshl3_add_u32 s56, s36, s24
    buffer_load_dwordx4 v72, s[12:15], s56 offen offset:0 lds
    v_mfma_f32_16x16x32_bf16 v[20:23], a[40:43], a[0:3], v[20:23]
    ds_read_b128 a[28:31], v111 offset:40960
    v_mfma_f32_16x16x32_bf16 v[198:201], a[40:43], a[4:7], v[198:201]
    ds_read_b128 a[32:35], v111 offset:43008
    v_mfma_f32_16x16x32_bf16 v[202:205], a[40:43], a[8:11], v[202:205]
    buffer_load_dwordx4 v162, s[12:15], s56 offen offset:1024 lds
    v_mfma_f32_16x16x32_bf16 v[206:209], a[40:43], a[12:15], v[206:209]
    ds_read_b64_tr_b16 a[52:53], v105 offset:49152
    v_mfma_f32_16x16x32_bf16 v[210:213], a[40:43], a[16:19], v[210:213]
    ds_read_b64_tr_b16 a[54:55], v105 offset:57344
    v_mfma_f32_16x16x32_bf16 v[214:217], a[44:47], a[4:7], v[214:217]
    buffer_load_dwordx4 v163, s[12:15], s56 offen offset:2048 lds
    v_mfma_f32_16x16x32_bf16 v[218:221], a[44:47], a[8:11], v[218:221]
    ds_read_b64_tr_b16 a[56:57], v106 offset:49152
    v_mfma_f32_16x16x32_bf16 v[222:225], a[44:47], a[12:15], v[222:225]
    ds_read_b64_tr_b16 a[58:59], v106 offset:57344
    v_mfma_f32_16x16x32_bf16 v[226:229], a[44:47], a[16:19], v[226:229]
    buffer_load_dwordx4 v164, s[12:15], s56 offen offset:3072 lds
    s_waitcnt vmcnt(12) lgkmcnt(0)
    s_barrier
    v_mfma_f32_16x16x32_bf16 v[16:19], a[48:51], a[0:3], v[16:19]
    ds_read_b64_tr_b16 a[36:37], v107 offset:0
    v_mfma_f32_16x16x32_bf16 v[182:185], a[48:51], a[20:23], v[182:185]
    ds_read_b64_tr_b16 a[38:39], v107 offset:8192
    v_mfma_f32_16x16x32_bf16 v[186:189], a[48:51], a[24:27], v[186:189]
    s_add_u32 m0, s62, 4096
    s_lshl3_add_u32 s56, s37, s24
    buffer_load_dwordx4 v72, s[12:15], s56 offen offset:0 lds
    v_mfma_f32_16x16x32_bf16 v[190:193], a[48:51], a[28:31], v[190:193]
    ds_read_b128 a[4:7], v112 offset:0
    v_mfma_f32_16x16x32_bf16 v[194:197], a[48:51], a[32:35], v[194:197]
    ds_read_b128 a[8:11], v112 offset:2048
    v_mfma_f32_16x16x32_bf16 v[20:23], a[52:55], a[0:3], v[20:23]
    buffer_load_dwordx4 v162, s[12:15], s56 offen offset:1024 lds
    v_mfma_f32_16x16x32_bf16 v[198:201], a[52:55], a[20:23], v[198:201]
    ds_read_b128 a[12:15], v112 offset:8192
    v_mfma_f32_16x16x32_bf16 v[202:205], a[52:55], a[24:27], v[202:205]
    ds_read_b128 a[16:19], v112 offset:10240
    v_mfma_f32_16x16x32_bf16 v[206:209], a[52:55], a[28:31], v[206:209]
    buffer_load_dwordx4 v163, s[12:15], s56 offen offset:2048 lds
    v_mfma_f32_16x16x32_bf16 v[210:213], a[52:55], a[32:35], v[210:213]
    ds_read_b64_tr_b16 a[40:41], v108 offset:0
    v_mfma_f32_16x16x32_bf16 v[214:217], a[56:59], a[20:23], v[214:217]
    ds_read_b64_tr_b16 a[42:43], v108 offset:8192
    v_mfma_f32_16x16x32_bf16 v[218:221], a[56:59], a[24:27], v[218:221]
    buffer_load_dwordx4 v164, s[12:15], s56 offen offset:3072 lds
    v_mfma_f32_16x16x32_bf16 v[222:225], a[56:59], a[28:31], v[222:225]
    ds_read_b64_tr_b16 a[44:45], v109 offset:0
    v_mfma_f32_16x16x32_bf16 v[226:229], a[56:59], a[32:35], v[226:229]
    ds_read_b64_tr_b16 a[46:47], v109 offset:8192
    s_waitcnt vmcnt(8)
    v_cmp_ne_u32 vcc, s79, v117
    s_cbranch_vccnz L_retryp1
L_backp1:
    s_waitcnt lgkmcnt(0)
    s_barrier
    v_mfma_f32_16x16x32_bf16 v[16:19], a[36:39], a[0:3], v[16:19]
    ds_read_b64_tr_b16 a[48:49], v107 offset:16384
    v_mfma_f32_16x16x32_bf16 v[182:185], a[36:39], a[4:7], v[182:185]
    ds_read_b64_tr_b16 a[50:51], v107 offset:24576
    v_mfma_f32_16x16x32_bf16 v[186:189], a[36:39], a[8:11], v[186:189]
    buffer_load_dwordx4 v[44:47], v66, s[16:19], s1 offen sc1
    v_mfma_f32_16x16x32_bf16 v[190:193], a[36:39], a[12:15], v[190:193]
    ds_read_b128 a[20:23], v113 offset:0
    v_mfma_f32_16x16x32_bf16 v[194:197], a[36:39], a[16:19], v[194:197]
    ds_read_b128 a[24:27], v113 offset:2048
    v_mfma_f32_16x16x32_bf16 v[20:23], a[40:43], a[0:3], v[20:23]
    s_lshl1_add_u32 m0, s87, 139776
    s_nop 0
    buffer_load_dwordx4 v67, s[16:19], s22 offen offset:0 sc1 lds
    v_mfma_f32_16x16x32_bf16 v[198:201], a[40:43], a[4:7], v[198:201]
    ds_read_b128 a[28:31], v113 offset:8192
    v_mfma_f32_16x16x32_bf16 v[202:205], a[40:43], a[8:11], v[202:205]
    ds_read_b128 a[32:35], v113 offset:10240
    v_mfma_f32_16x16x32_bf16 v[206:209], a[40:43], a[12:15], v[206:209]
    s_add_u32 s22, s22, 261120
    buffer_load_dwordx4 v67, s[16:19], s22 offen offset:1024 sc1 lds
    v_mfma_f32_16x16x32_bf16 v[210:213], a[40:43], a[16:19], v[210:213]
    ds_read_b64_tr_b16 a[52:53], v108 offset:16384
    v_mfma_f32_16x16x32_bf16 v[214:217], a[44:47], a[4:7], v[214:217]
    ds_read_b64_tr_b16 a[54:55], v108 offset:24576
    v_mfma_f32_16x16x32_bf16 v[218:221], a[44:47], a[8:11], v[218:221]
    ds_read_b64_tr_b16 a[56:57], v109 offset:16384
    v_mfma_f32_16x16x32_bf16 v[222:225], a[44:47], a[12:15], v[222:225]
    ds_read_b64_tr_b16 a[58:59], v109 offset:24576
    v_mfma_f32_16x16x32_bf16 v[226:229], a[44:47], a[16:19], v[226:229]
    s_waitcnt vmcnt(12) lgkmcnt(0)
    s_barrier
    v_mfma_f32_16x16x32_bf16 v[16:19], a[48:51], a[0:3], v[16:19]
    ds_read_b64_tr_b16 a[36:37], v107 offset:32768
    v_mfma_f32_16x16x32_bf16 v[182:185], a[48:51], a[20:23], v[182:185]
    ds_read_b64_tr_b16 a[38:39], v107 offset:40960
    v_mfma_f32_16x16x32_bf16 v[186:189], a[48:51], a[24:27], v[186:189]
    s_lshl1_add_u32 m0, s87, 139776
    s_add_u32 s22, s22, 261120
    buffer_load_dwordx4 v67, s[16:19], s22 offen offset:2048 sc1 lds
    v_mfma_f32_16x16x32_bf16 v[190:193], a[48:51], a[28:31], v[190:193]
    ds_read_b128 a[4:7], v112 offset:32768
    v_mfma_f32_16x16x32_bf16 v[194:197], a[48:51], a[32:35], v[194:197]
    ds_read_b128 a[8:11], v112 offset:34816
    v_mfma_f32_16x16x32_bf16 v[20:23], a[52:55], a[0:3], v[20:23]
    s_add_u32 s22, s22, 261120
    buffer_load_dwordx4 v67, s[16:19], s22 offen offset:3072 sc1 lds
    v_mfma_f32_16x16x32_bf16 v[198:201], a[52:55], a[20:23], v[198:201]
    ds_read_b128 a[12:15], v112 offset:40960
    v_mfma_f32_16x16x32_bf16 v[202:205], a[52:55], a[24:27], v[202:205]
    ds_read_b128 a[16:19], v112 offset:43008
    v_mfma_f32_16x16x32_bf16 v[206:209], a[52:55], a[28:31], v[206:209]
    ds_read_b64_tr_b16 a[40:41], v108 offset:32768
    v_mfma_f32_16x16x32_bf16 v[210:213], a[52:55], a[32:35], v[210:213]
    ds_read_b64_tr_b16 a[42:43], v108 offset:40960
    v_mfma_f32_16x16x32_bf16 v[214:217], a[56:59], a[20:23], v[214:217]
    ds_read_b64_tr_b16 a[44:45], v109 offset:32768
    v_mfma_f32_16x16x32_bf16 v[218:221], a[56:59], a[24:27], v[218:221]
    ds_read_b64_tr_b16 a[46:47], v109 offset:40960
    v_mfma_f32_16x16x32_bf16 v[222:225], a[56:59], a[28:31], v[222:225]
    v_mfma_f32_16x16x32_bf16 v[226:229], a[56:59], a[32:35], v[226:229]
    s_waitcnt lgkmcnt(0)
    v_mfma_f32_16x16x32_bf16 v[16:19], a[36:39], a[0:3], v[16:19]
    ds_read_b64_tr_b16 a[48:49], v107 offset:49152
    v_mfma_f32_16x16x32_bf16 v[182:185], a[36:39], a[4:7], v[182:185]
    ds_read_b64_tr_b16 a[50:51], v107 offset:57344
    v_mfma_f32_16x16x32_bf16 v[186:189], a[36:39], a[8:11], v[186:189]
    s_add_u32 m0, s62, 32768
    s_lshl3_add_u32 s56, s38, s24
    buffer_load_dwordx4 v72, s[12:15], s56 offen offset:0 lds
    v_mfma_f32_16x16x32_bf16 v[190:193], a[36:39], a[12:15], v[190:193]
    ds_read_b128 a[20:23], v113 offset:32768
    v_mfma_f32_16x16x32_bf16 v[194:197], a[36:39], a[16:19], v[194:197]
    ds_read_b128 a[24:27], v113 offset:34816
    v_mfma_f32_16x16x32_bf16 v[20:23], a[40:43], a[0:3], v[20:23]
    buffer_load_dwordx4 v162, s[12:15], s56 offen offset:1024 lds
    v_mfma_f32_16x16x32_bf16 v[198:201], a[40:43], a[4:7], v[198:201]
    ds_read_b128 a[28:31], v113 offset:40960
    v_mfma_f32_16x16x32_bf16 v[202:205], a[40:43], a[8:11], v[202:205]
    ds_read_b128 a[32:35], v113 offset:43008
    v_mfma_f32_16x16x32_bf16 v[206:209], a[40:43], a[12:15], v[206:209]
    buffer_load_dwordx4 v163, s[12:15], s56 offen offset:2048 lds
    v_mfma_f32_16x16x32_bf16 v[210:213], a[40:43], a[16:19], v[210:213]
    ds_read_b64_tr_b16 a[52:53], v108 offset:49152
    v_mfma_f32_16x16x32_bf16 v[214:217], a[44:47], a[4:7], v[214:217]
    ds_read_b64_tr_b16 a[54:55], v108 offset:57344
    v_mfma_f32_16x16x32_bf16 v[218:221], a[44:47], a[8:11], v[218:221]
    buffer_load_dwordx4 v164, s[12:15], s56 offen offset:3072 lds
    v_mfma_f32_16x16x32_bf16 v[222:225], a[44:47], a[12:15], v[222:225]
    ds_read_b64_tr_b16 a[56:57], v109 offset:49152
    v_mfma_f32_16x16x32_bf16 v[226:229], a[44:47], a[16:19], v[226:229]
    ds_read_b64_tr_b16 a[58:59], v109 offset:57344
    s_waitcnt lgkmcnt(0)
    s_barrier
    v_mfma_f32_16x16x32_bf16 v[16:19], a[48:51], a[0:3], v[16:19]
    v_mfma_f32_16x16x32_bf16 v[182:185], a[48:51], a[20:23], v[182:185]
    v_mfma_f32_16x16x32_bf16 v[186:189], a[48:51], a[24:27], v[186:189]
    v_mfma_f32_16x16x32_bf16 v[190:193], a[48:51], a[28:31], v[190:193]
    v_mfma_f32_16x16x32_bf16 v[194:197], a[48:51], a[32:35], v[194:197]
    v_mfma_f32_16x16x32_bf16 v[20:23], a[52:55], a[0:3], v[20:23]
    v_mfma_f32_16x16x32_bf16 v[198:201], a[52:55], a[20:23], v[198:201]
    v_mfma_f32_16x16x32_bf16 v[202:205], a[52:55], a[24:27], v[202:205]
    v_mfma_f32_16x16x32_bf16 v[206:209], a[52:55], a[28:31], v[206:209]
    v_mfma_f32_16x16x32_bf16 v[210:213], a[52:55], a[32:35], v[210:213]
    ds_write_b128 v103, v[16:19]
    v_mfma_f32_16x16x32_bf16 v[214:217], a[56:59], a[20:23], v[214:217]
    s_waitcnt vmcnt(8)
    v_mfma_f32_16x16x32_bf16 v[218:221], a[56:59], a[24:27], v[218:221]
    v_mov_b32 v48, v45
    v_mfma_f32_16x16x32_bf16 v[222:225], a[56:59], a[28:31], v[222:225]
    v_mov_b32 v50, v47
    v_mfma_f32_16x16x32_bf16 v[226:229], a[56:59], a[32:35], v[226:229]
    v_pk_fma_f32 v[182:183], v[16:17], v[44:45], v[182:183] op_sel_hi:[1,0,1]
    v_pk_fma_f32 v[184:185], v[18:19], v[44:45], v[184:185] op_sel_hi:[1,0,1]
    v_pk_fma_f32 v[186:187], v[16:17], v[48:49], v[186:187] op_sel_hi:[1,0,1]
    v_pk_fma_f32 v[188:189], v[18:19], v[48:49], v[188:189] op_sel_hi:[1,0,1]
    v_cvt_pk_bf16_f32 v230, v182, v183
    v_cvt_pk_bf16_f32 v231, v184, v185
    v_cvt_pk_bf16_f32 v232, v186, v187
    v_cvt_pk_bf16_f32 v233, v188, v189
    v_pk_max_i16 v230, v230, 0
    v_pk_max_i16 v232, v232, 0
    v_pk_max_i16 v231, v231, 0
    v_pk_max_i16 v233, v233, 0
    v_permlane16_swap_b32 v230, v232
    s_nop 0
    v_permlane16_swap_b32 v231, v233
    buffer_store_dwordx4 v[230:233], v4, s[16:19], s25 offen offset:0 sc1
    v_pk_fma_f32 v[190:191], v[16:17], v[46:47], v[190:191] op_sel_hi:[1,0,1]
    v_pk_fma_f32 v[192:193], v[18:19], v[46:47], v[192:193] op_sel_hi:[1,0,1]
    v_pk_fma_f32 v[194:195], v[16:17], v[50:51], v[194:195] op_sel_hi:[1,0,1]
    v_pk_fma_f32 v[196:197], v[18:19], v[50:51], v[196:197] op_sel_hi:[1,0,1]
    v_cvt_pk_bf16_f32 v234, v190, v191
    v_cvt_pk_bf16_f32 v235, v192, v193
    v_cvt_pk_bf16_f32 v236, v194, v195
    v_cvt_pk_bf16_f32 v237, v196, v197
    v_pk_max_i16 v234, v234, 0
    v_pk_max_i16 v236, v236, 0
    v_pk_max_i16 v235, v235, 0
    v_pk_max_i16 v237, v237, 0
    v_permlane16_swap_b32 v234, v236
    s_nop 0
    v_permlane16_swap_b32 v235, v237
    buffer_store_dwordx4 v[234:237], v4, s[16:19], s25 offen offset:1024 sc1
    s_waitcnt vmcnt(6) lgkmcnt(0)
    s_barrier
    ds_read_b128 v[24:27], v114
    ds_read_b64 v[52:53], v68 offset:0
    ds_read_b64 v[54:55], v68 offset:2048
    ds_read_b64 v[56:57], v68 offset:1024
    ds_read_b64 v[58:59], v68 offset:3072
    ds_read2st64_b32 v[92:93], v124 offset0:0 offset1:4
    ds_read2st64_b32 v[94:95], v124 offset0:8 offset1:12
    ds_read2st64_b32 v[96:97], v125 offset0:0 offset1:4
    ds_read2st64_b32 v[98:99], v125 offset0:8 offset1:12
    v_pk_fma_f32 v[198:199], v[20:21], v[44:45], v[198:199] op_sel_hi:[1,0,1]
    v_pk_fma_f32 v[200:201], v[22:23], v[44:45], v[200:201] op_sel_hi:[1,0,1]
    v_pk_fma_f32 v[202:203], v[20:21], v[48:49], v[202:203] op_sel_hi:[1,0,1]
    v_pk_fma_f32 v[204:205], v[22:23], v[48:49], v[204:205] op_sel_hi:[1,0,1]
    v_cvt_pk_bf16_f32 v238, v198, v199
    v_cvt_pk_bf16_f32 v239, v200, v201
    v_cvt_pk_bf16_f32 v240, v202, v203
    v_cvt_pk_bf16_f32 v241, v204, v205
    v_pk_max_i16 v238, v238, 0
    v_pk_max_i16 v240, v240, 0
    v_pk_max_i16 v239, v239, 0
    v_pk_max_i16 v241, v241, 0
    v_permlane16_swap_b32 v238, v240
    s_nop 0
    v_permlane16_swap_b32 v239, v241
    buffer_store_dwordx4 v[238:241], v4, s[16:19], s26 offen offset:0 sc1
    v_pk_fma_f32 v[206:207], v[20:21], v[46:47], v[206:207] op_sel_hi:[1,0,1]
    v_pk_fma_f32 v[208:209], v[22:23], v[46:47], v[208:209] op_sel_hi:[1,0,1]
    v_pk_fma_f32 v[210:211], v[20:21], v[50:51], v[210:211] op_sel_hi:[1,0,1]
    v_pk_fma_f32 v[212:213], v[22:23], v[50:51], v[212:213] op_sel_hi:[1,0,1]
    v_cvt_pk_bf16_f32 v242, v206, v207
    v_cvt_pk_bf16_f32 v243, v208, v209
    v_cvt_pk_bf16_f32 v244, v210, v211
    v_cvt_pk_bf16_f32 v245, v212, v213
    v_pk_max_i16 v242, v242, 0
    v_pk_max_i16 v244, v244, 0
    v_pk_max_i16 v243, v243, 0
    v_pk_max_i16 v245, v245, 0
    v_permlane16_swap_b32 v242, v244
    s_nop 0
    v_permlane16_swap_b32 v243, v245
    buffer_store_dwordx4 v[242:245], v4, s[16:19], s26 offen offset:1024 sc1
    s_waitcnt lgkmcnt(0)
    v_pk_fma_f32 v[214:215], v[24:25], v[44:45], v[214:215] op_sel_hi:[1,0,1]
    v_pk_fma_f32 v[216:217], v[26:27], v[44:45], v[216:217] op_sel_hi:[1,0,1]
    v_pk_fma_f32 v[218:219], v[24:25], v[48:49], v[218:219] op_sel_hi:[1,0,1]
    v_pk_fma_f32 v[220:221], v[26:27], v[48:49], v[220:221] op_sel_hi:[1,0,1]
    v_cvt_pk_bf16_f32 v246, v214, v215
    v_cvt_pk_bf16_f32 v247, v216, v217
    v_cvt_pk_bf16_f32 v248, v218, v219
    v_cvt_pk_bf16_f32 v249, v220, v221
    v_pk_max_i16 v246, v246, 0
    v_pk_max_i16 v248, v248, 0
    v_pk_max_i16 v247, v247, 0
    v_pk_max_i16 v249, v249, 0
    v_permlane16_swap_b32 v246, v248
    s_nop 0
    v_permlane16_swap_b32 v247, v249
    buffer_store_dwordx4 v[246:249], v4, s[16:19], s27 offen offset:0 sc1
    v_pk_fma_f32 v[222:223], v[24:25], v[46:47], v[222:223] op_sel_hi:[1,0,1]
    v_pk_fma_f32 v[224:225], v[26:27], v[46:47], v[224:225] op_sel_hi:[1,0,1]
    v_pk_fma_f32 v[226:227], v[24:25], v[50:51], v[226:227] op_sel_hi:[1,0,1]
    v_pk_fma_f32 v[228:229], v[26:27], v[50:51], v[228:229] op_sel_hi:[1,0,1]
    v_cvt_pk_bf16_f32 v250, v222, v223
    v_cvt_pk_bf16_f32 v251, v224, v225
    v_cvt_pk_bf16_f32 v252, v226, v227
    v_cvt_pk_bf16_f32 v253, v228, v229
    v_pk_max_i16 v250, v250, 0
    v_pk_max_i16 v252, v252, 0
    v_pk_max_i16 v251, v251, 0
    v_pk_max_i16 v253, v253, 0
    v_permlane16_swap_b32 v250, v252
    s_nop 0
    v_permlane16_swap_b32 v251, v253
    buffer_store_dwordx4 v[250:253], v4, s[16:19], s27 offen offset:1024 sc1
    v_swap_b32 v53, v56
    v_swap_b32 v55, v58
    v_lshlrev_b32 v138, 16, v92
    v_lshlrev_b32 v139, 16, v93
    v_mfma_f32_16x16x32_bf16 v[60:63], v[52:55], v[36:39], 0
    v_mfma_f32_16x16x32_bf16 v[120:123], v[52:55], v[40:43], 0
    v_mfma_f32_16x16x32_bf16 v[126:129], v[56:59], v[36:39], 0
    v_mfma_f32_16x16x32_bf16 v[130:133], v[56:59], v[40:43], 0
    v_lshlrev_b32 v140, 16, v94
    v_lshlrev_b32 v141, 16, v95
    v_lshlrev_b32 v142, 16, v96
    v_lshlrev_b32 v143, 16, v97
    v_lshlrev_b32 v144, 16, v98
    v_lshlrev_b32 v145, 16, v99
    v_pk_mul_f32 v[134:135], v[120:121], v[88:89]
    v_pk_mul_f32 v[136:137], v[60:61], v[88:89]
    v_pk_fma_f32 v[60:61], v[60:61], v[84:85], v[134:135]
    v_pk_fma_f32 v[120:121], v[120:121], v[84:85], v[136:137] neg_lo:[0,0,1] neg_hi:[0,0,1]
    v_pk_mul_f32 v[134:135], v[122:123], v[90:91]
    v_pk_mul_f32 v[136:137], v[62:63], v[90:91]
    v_pk_fma_f32 v[62:63], v[62:63], v[86:87], v[134:135]
    v_pk_fma_f32 v[122:123], v[122:123], v[86:87], v[136:137] neg_lo:[0,0,1] neg_hi:[0,0,1]
    v_cvt_pk_bf16_f32 v52, v60, v120
    v_cvt_pk_bf16_f32 v53, v61, v121
    v_cvt_pk_bf16_f32 v54, v62, v122
    v_cvt_pk_bf16_f32 v55, v63, v123
    v_and_b32 v146, 0xffff0000, v92
    v_and_b32 v147, 0xffff0000, v93
    v_mfma_f32_16x16x32_bf16 v[60:63], v[36:39], v[52:55], 0
    v_mfma_f32_16x16x32_bf16 v[120:123], v[40:43], v[52:55], 0
    v_and_b32 v148, 0xffff0000, v94
    v_and_b32 v149, 0xffff0000, v95
    v_pk_mul_f32 v[134:135], v[130:131], v[88:89]
    v_pk_mul_f32 v[136:137], v[126:127], v[88:89]
    v_pk_fma_f32 v[126:127], v[126:127], v[84:85], v[134:135]
    v_pk_fma_f32 v[130:131], v[130:131], v[84:85], v[136:137] neg_lo:[0,0,1] neg_hi:[0,0,1]
    v_pk_mul_f32 v[134:135], v[132:133], v[90:91]
    v_pk_mul_f32 v[136:137], v[128:129], v[90:91]
    v_pk_fma_f32 v[128:129], v[128:129], v[86:87], v[134:135]
    v_pk_fma_f32 v[132:133], v[132:133], v[86:87], v[136:137] neg_lo:[0,0,1] neg_hi:[0,0,1]
    v_cvt_pk_bf16_f32 v56, v126, v130
    v_cvt_pk_bf16_f32 v57, v127, v131
    v_cvt_pk_bf16_f32 v58, v128, v132
    s_add_u32 m0, s62, 36864
    s_lshl3_add_u32 s56, s39, s24
    buffer_load_dwordx4 v72, s[12:15], s56 offen offset:0 lds
    v_cvt_pk_bf16_f32 v59, v129, v133
    v_and_b32 v150, 0xffff0000, v96
    v_and_b32 v151, 0xffff0000, v97
    v_mfma_f32_16x16x32_bf16 v[126:129], v[36:39], v[56:59], 0
    v_mfma_f32_16x16x32_bf16 v[130:133], v[40:43], v[56:59], 0
    v_and_b32 v152, 0xffff0000, v98
    v_and_b32 v153, 0xffff0000, v99
    v_pk_mul_f32 v[134:135], v[120:121], v[142:143]
    v_pk_mul_f32 v[136:137], v[60:61], v[142:143]
    v_pk_fma_f32 v[60:61], v[60:61], v[138:139], v[134:135] neg_lo:[0,0,1] neg_hi:[0,0,1]
    v_pk_fma_f32 v[120:121], v[120:121], v[138:139], v[136:137]
    v_pk_mul_f32 v[134:135], v[122:123], v[144:145]
    v_pk_mul_f32 v[136:137], v[62:63], v[144:145]
    v_pk_fma_f32 v[62:63], v[62:63], v[140:141], v[134:135] neg_lo:[0,0,1] neg_hi:[0,0,1]
    v_pk_fma_f32 v[122:123], v[122:123], v[140:141], v[136:137]
    v_cvt_pk_bf16_f32 v52, v60, v120
    buffer_load_dwordx4 v162, s[12:15], s56 offen offset:1024 lds
    v_cvt_pk_bf16_f32 v53, v61, v121
    v_cvt_pk_bf16_f32 v54, v62, v122
    v_cvt_pk_bf16_f32 v55, v63, v123
    s_nop 1
    v_mfma_f32_16x16x32_bf16 v[60:63], v[52:55], v[154:157], 0
    v_mfma_f32_16x16x32_bf16 v[120:123], v[52:55], v[158:161], 0
    v_pk_mul_f32 v[134:135], v[130:131], v[150:151]
    v_pk_mul_f32 v[136:137], v[126:127], v[150:151]
    v_pk_fma_f32 v[126:127], v[126:127], v[146:147], v[134:135] neg_lo:[0,0,1] neg_hi:[0,0,1]
    v_pk_fma_f32 v[130:131], v[130:131], v[146:147], v[136:137]
    v_pk_mul_f32 v[134:135], v[132:133], v[152:153]
    v_pk_mul_f32 v[136:137], v[128:129], v[152:153]
    v_pk_fma_f32 v[128:129], v[128:129], v[148:149], v[134:135] neg_lo:[0,0,1] neg_hi:[0,0,1]
    v_pk_fma_f32 v[132:133], v[132:133], v[148:149], v[136:137]
    v_cvt_pk_bf16_f32 v56, v126, v130
    v_cvt_pk_bf16_f32 v57, v127, v131
    v_cvt_pk_bf16_f32 v58, v128, v132
    buffer_load_dwordx4 v163, s[12:15], s56 offen offset:2048 lds
    v_cvt_pk_bf16_f32 v59, v129, v133
    s_nop 1
    v_mfma_f32_16x16x32_bf16 v[126:129], v[56:59], v[154:157], 0
    v_mfma_f32_16x16x32_bf16 v[130:133], v[56:59], v[158:161], 0
    v_pk_mul_f32 v[134:135], v[120:121], v[88:89]
    v_pk_mul_f32 v[136:137], v[60:61], v[88:89]
    v_pk_fma_f32 v[60:61], v[60:61], v[84:85], v[134:135] neg_lo:[0,0,1] neg_hi:[0,0,1]
    v_pk_fma_f32 v[120:121], v[120:121], v[84:85], v[136:137]
    v_pk_mul_f32 v[134:135], v[122:123], v[90:91]
    v_pk_mul_f32 v[136:137], v[62:63], v[90:91]
    v_pk_fma_f32 v[62:63], v[62:63], v[86:87], v[134:135] neg_lo:[0,0,1] neg_hi:[0,0,1]
    v_pk_fma_f32 v[122:123], v[122:123], v[86:87], v[136:137]
    v_cvt_pk_bf16_f32 v52, v60, v120
    v_cvt_pk_bf16_f32 v53, v61, v121
    v_cvt_pk_bf16_f32 v54, v62, v122
    v_cvt_pk_bf16_f32 v55, v63, v123
    s_nop 1
    v_mfma_f32_16x16x32_bf16 v[60:63], v[154:157], v[52:55], 0
    buffer_load_dwordx4 v164, s[12:15], s56 offen offset:3072 lds
    v_mfma_f32_16x16x32_bf16 v[120:123], v[158:161], v[52:55], 0
    v_pk_mul_f32 v[134:135], v[130:131], v[88:89]
    v_pk_mul_f32 v[136:137], v[126:127], v[88:89]
    v_pk_fma_f32 v[126:127], v[126:127], v[84:85], v[134:135] neg_lo:[0,0,1] neg_hi:[0,0,1]
    v_pk_fma_f32 v[130:131], v[130:131], v[84:85], v[136:137]
    v_pk_mul_f32 v[134:135], v[132:133], v[90:91]
    v_pk_mul_f32 v[136:137], v[128:129], v[90:91]
    v_pk_fma_f32 v[128:129], v[128:129], v[86:87], v[134:135] neg_lo:[0,0,1] neg_hi:[0,0,1]
    v_pk_fma_f32 v[132:133], v[132:133], v[86:87], v[136:137]
    v_cvt_pk_bf16_f32 v56, v126, v130
    v_cvt_pk_bf16_f32 v57, v127, v131
    v_cvt_pk_bf16_f32 v58, v128, v132
    v_cvt_pk_bf16_f32 v59, v129, v133
    s_nop 1
    v_mfma_f32_16x16x32_bf16 v[126:129], v[154:157], v[56:59], 0
    v_mfma_f32_16x16x32_bf16 v[130:133], v[158:161], v[56:59], 0
    v_cvt_pk_bf16_f32 v92, v60, v120
    v_cvt_pk_bf16_f32 v94, v61, v121
    v_cvt_pk_bf16_f32 v96, v62, v122
    v_cvt_pk_bf16_f32 v98, v63, v123
    s_nop 3
    v_cvt_pk_bf16_f32 v93, v126, v130
    v_cvt_pk_bf16_f32 v95, v127, v131
    v_cvt_pk_bf16_f32 v97, v128, v132
    v_cvt_pk_bf16_f32 v99, v129, v133
    ds_write_b64 v69, v[92:93] offset:0
    ds_write_b64 v69, v[94:95] offset:512
    ds_write_b64 v69, v[96:97] offset:1024
    ds_write_b64 v69, v[98:99] offset:1536
    v_mov_b32 v44, -1
    v_mov_b32 v45, -1
    v_mov_b32 v46, -1
    v_mov_b32 v47, -1
    s_add_u32 s48, s48, 12582912
    s_add_u32 s49, s48, 262144
    buffer_store_dwordx4 v[44:47], v4, s[16:19], s48 offen sc1
    buffer_store_dwordx4 v[44:47], v4, s[16:19], s49 offen sc1
    s_waitcnt vmcnt(6) lgkmcnt(0)
    s_barrier
    ds_read_b128 v[52:55], v5 offset:0
    ds_read_b128 v[56:59], v5 offset:1024
    s_mov_b64 exec, 1
    buffer_store_dword v11, off, s[16:19], s51 sc1
    s_mov_b64 exec, -1
    v_add_u32 v44, s62, v73
    v_xor_b32 v45, 64, v44
    v_add_u32 v46, 65536, v44
    v_add_u32 v47, 65536, v45
    s_waitcnt lgkmcnt(0)
    buffer_store_dwordx4 v[52:55], v70, s[16:19], s23 offen offset:0 sc1
    buffer_store_dwordx4 v[56:59], v70, s[16:19], s23 offen offset:1024 sc1
    s_add_u32 m0, s62, 65536
    s_lshl3_add_u32 s56, s40, s24
    buffer_load_dwordx4 v72, s[12:15], s56 offen offset:0 lds
    buffer_load_dwordx4 v162, s[12:15], s56 offen offset:1024 lds
    buffer_load_dwordx4 v163, s[12:15], s56 offen offset:2048 lds
    buffer_load_dwordx4 v164, s[12:15], s56 offen offset:3072 lds
    s_waitcnt vmcnt(19)
    s_lshl_b32 s54, s3, 14
    ds_read_b64_tr_b16 a[0:1], v44 offset:0
    s_lshl_b32 s55, s53, 5
    v_xor_b32 v77, s55, v77
    ds_read_b64_tr_b16 a[2:3], v44 offset:512
    s_add_u32 s10, s54, 4194304
    s_add_u32 s11, s10, 7168
    ds_read_b64_tr_b16 a[4:5], v45 offset:0
    s_lshl_b32 s54, s3, 8
    v_add_u32 v78, s54, v78
    ds_read_b64_tr_b16 a[6:7], v45 offset:512
    v_add_u32 v79, s85, v79
    v_add_u32 v80, s84, v80
    ds_read_b64_tr_b16 a[8:9], v44 offset:2048
    v_add_u32 v81, s84, v81
    v_add_u32 v82, s84, v82
    ds_read_b64_tr_b16 a[10:11], v44 offset:2560
    v_add_u32 v83, s84, v83
    v_lshlrev_b32 v9, 30, v3
    ds_read_b64_tr_b16 a[12:13], v45 offset:2048
    v_and_b32 v9, 0x80000000, v9
    v_xor_b32 v104, v154, v9
    ds_read_b64_tr_b16 a[14:15], v45 offset:2560
    v_xor_b32 v108, v158, v9
    v_xor_b32 v105, v155, v9
    ds_read_b64_tr_b16 a[16:17], v44 offset:4096
    v_xor_b32 v109, v159, v9
    v_xor_b32 v106, v156, v9
    ds_read_b64_tr_b16 a[18:19], v44 offset:4608
    v_xor_b32 v110, v160, v9
    v_xor_b32 v107, v157, v9
    ds_read_b64_tr_b16 a[20:21], v45 offset:4096
    v_xor_b32 v111, v161, v9
    s_mul_i32 s54, s3, 8704
    ds_read_b64_tr_b16 a[22:23], v45 offset:4608
    v_add_u32 v74, s54, v74
    s_mul_i32 s54, s3, 2176
    ds_read_b64_tr_b16 a[24:25], v44 offset:6144
    v_add_u32 v75, s54, v75
    s_lshl_b32 s54, s47, 11
    ds_read_b64_tr_b16 a[26:27], v44 offset:6656
    s_and_b32 s55, s3, 1
    s_lshl4_add_u32 s54, s55, s54
    ds_read_b64_tr_b16 a[28:29], v45 offset:6144
    s_lshr_b32 s55, s3, 1
    s_lshl2_add_u32 s54, s55, s54
    ds_read_b64_tr_b16 a[30:31], v45 offset:6656
    s_add_u32 s54, s54, 14811136
    v_lshrrev_b32 v9, 3, v1
    ds_read_b64_tr_b16 a[32:33], v44 offset:32768
    v_lshl_add_u32 v100, v9, 8, s54
    s_lshl_b32 s54, s3, 5
    ds_read_b64_tr_b16 a[34:35], v44 offset:33280
    s_add_u32 s54, s54, s47
    s_lshl_b32 s54, s54, 6
    ds_read_b64_tr_b16 a[36:37], v45 offset:32768
    s_add_u32 s54, s54, s52
    s_lshl_b32 s0, s54, 7
    ds_read_b64_tr_b16 a[38:39], v45 offset:33280
    s_add_u32 s1, s0, 1048576
    s_add_u32 s8, s0, 12582912
    ds_read_b64_tr_b16 a[40:41], v44 offset:34816
    s_add_u32 s9, s1, 12582912
    s_mul_i32 s54, s47, 86
    ds_read_b64_tr_b16 a[42:43], v44 offset:35328
    s_mul_i32 s55, s3, 22
    s_add_u32 s54, s54, s55
    ds_read_b64_tr_b16 a[44:45], v45 offset:34816
    s_lshl_b32 s54, s54, 11
    s_add_u32 s54, s54, 6291456
    ds_read_b64_tr_b16 a[46:47], v45 offset:35328
    s_add_u32 s32, s16, s54
    s_addc_u32 s33, s17, 0
    s_cmp_eq_u32 s3, 3
    s_cselect_b32 s34, 20, 22
    s_lshl_b32 s34, s34, 11
    s_mov_b32 s35, 0x20000
    v_add_u32 v115, 8192, v115
    v_lshrrev_b32 v9, 3, v2
    v_and_b32 v5, 3, v2
    v_lshl_add_u32 v9, v9, 2, v5
    v_lshl_add_u32 v9, v9, 8, s53
    v_lshrrev_b32 v5, 5, v1
    v_mul_u32_u24 v36, v5, v9
    v_lshlrev_b32 v36, 2, v36
    v_lshrrev_b32 v5, 2, v1
    v_xor_b32 v5, v5, v3
    v_and_b32 v5, 1, v5
    v_cmp_eq_u32 vcc, 0, v5
    v_cvt_f32_u32 v36, v36
    v_cvt_f32_u32 v9, v9
    v_mul_f32 v40, 0x3a000000, v36
    v_mul_f32 v9, 0x3a000000, v9
    v_add_f32 v41, v40, v9
    v_add_f32 v42, v41, v9
    v_add_f32 v43, v42, v9
    v_cos_f32 v36, v40
    v_cos_f32 v37, v41
    v_cos_f32 v38, v42
    v_cos_f32 v39, v43
    v_sin_f32 v40, v40
    v_sin_f32 v41, v41
    v_sin_f32 v42, v42
    v_sin_f32 v43, v43
    v_cndmask_b32 v36, 0, v36, vcc
    v_cndmask_b32 v40, 0, v40, vcc
    v_cndmask_b32 v37, 0, v37, vcc
    v_cndmask_b32 v41, 0, v41, vcc
    v_cndmask_b32 v38, 0, v38, vcc
    v_cndmask_b32 v42, 0, v42, vcc
    v_cndmask_b32 v39, 0, v39, vcc
    v_cndmask_b32 v43, 0, v43, vcc
    v_cvt_pk_bf16_f32 v60, v36, -v40
    v_cvt_pk_bf16_f32 v64, v40, v36
    v_cvt_pk_bf16_f32 v61, v37, -v41
    v_cvt_pk_bf16_f32 v65, v41, v37
    v_cvt_pk_bf16_f32 v62, v38, -v42
    v_cvt_pk_bf16_f32 v66, v42, v38
    v_cvt_pk_bf16_f32 v63, v39, -v43
    v_cvt_pk_bf16_f32 v67, v43, v39
    s_waitcnt vmcnt(4)
    s_barrier
    s_add_u32 s56, s50, 8192
    s_mov_b64 exec, 255
    buffer_store_dword v11, v118, s[16:19], s56 offen sc1
    s_mov_b64 exec, -1
    ds_read_b64_tr_b16 a[48:49], v44 offset:36864
    s_add_u32 m0, s62, 69632
    s_lshl3_add_u32 s56, s41, s24
    buffer_load_dwordx4 v72, s[12:15], s56 offen offset:0 lds
    ds_read_b64_tr_b16 a[50:51], v44 offset:37376
    ds_read_b64_tr_b16 a[52:53], v45 offset:36864
    ds_read_b64_tr_b16 a[54:55], v45 offset:37376
    ds_read_b64_tr_b16 a[56:57], v44 offset:38912
    ds_read_b64_tr_b16 a[58:59], v44 offset:39424
    ds_read_b64_tr_b16 a[60:61], v45 offset:38912
    ds_read_b64_tr_b16 a[62:63], v45 offset:39424
    buffer_load_dwordx4 v162, s[12:15], s56 offen offset:1024 lds
    buffer_load_dwordx4 v163, s[12:15], s56 offen offset:2048 lds
    buffer_load_dwordx4 v164, s[12:15], s56 offen offset:3072 lds
    s_add_u32 m0, s62, 98304
    s_lshl3_add_u32 s56, s42, s24
    buffer_load_dwordx4 v72, s[12:15], s56 offen offset:0 lds
    buffer_load_dwordx4 v162, s[12:15], s56 offen offset:1024 lds
    buffer_load_dwordx4 v163, s[12:15], s56 offen offset:2048 lds
    buffer_load_dwordx4 v164, s[12:15], s56 offen offset:3072 lds
    s_add_u32 m0, s62, 102400
    s_lshl3_add_u32 s56, s43, s24
    buffer_load_dwordx4 v72, s[12:15], s56 offen offset:0 lds
    buffer_load_dwordx4 v162, s[12:15], s56 offen offset:1024 lds
    buffer_load_dwordx4 v163, s[12:15], s56 offen offset:2048 lds
    buffer_load_dwordx4 v164, s[12:15], s56 offen offset:3072 lds
    s_waitcnt lgkmcnt(0)
    buffer_load_dword v8, v116, s[16:19], 0 offen sc1
    s_add_u32 m0, s62, 0
    s_lshl3_add_u32 s56, s44, s24
    buffer_load_dwordx4 v72, s[12:15], s56 offen offset:0 lds
    buffer_load_dwordx4 v162, s[12:15], s56 offen offset:1024 lds
    buffer_load_dwordx4 v163, s[12:15], s56 offen offset:2048 lds
    buffer_load_dwordx4 v164, s[12:15], s56 offen offset:3072 lds
    s_add_u32 m0, s62, 4096
    s_lshl3_add_u32 s56, s45, s24
    buffer_load_dwordx4 v72, s[12:15], s56 offen offset:0 lds
    buffer_load_dwordx4 v162, s[12:15], s56 offen offset:1024 lds
    buffer_load_dwordx4 v163, s[12:15], s56 offen offset:2048 lds
    buffer_load_dwordx4 v164, s[12:15], s56 offen offset:3072 lds
    buffer_load_dwordx3 v[48:50], v100, s[16:19], 0 offen sc1
    buffer_load_dwordx4 v[12:15], v76, s[4:7], s0 offen
    buffer_load_dwordx4 v[16:19], v76, s[4:7], s1 offen
    s_waitcnt vmcnt(11)
    v_cmp_ne_u32 vcc, s79, v8
    s_cbranch_vccnz L_retryp2
L_backp2:
    ds_read_b64_tr_b16 a[64:65], v46 offset:0
    buffer_load_dwordx4 a[176:179], v4, s[32:35], s36 offen offset:0 sc1
    ds_read_b64_tr_b16 a[66:67], v46 offset:512
    ds_read_b64_tr_b16 a[68:69], v47 offset:0
    ds_read_b64_tr_b16 a[70:71], v47 offset:512
    buffer_load_dwordx4 a[180:183], v4, s[32:35], s36 offen offset:2048 sc1
    ds_read_b64_tr_b16 a[72:73], v46 offset:2048
    ds_read_b64_tr_b16 a[74:75], v46 offset:2560
    ds_read_b64_tr_b16 a[76:77], v47 offset:2048
    buffer_load_dwordx4 a[184:187], v4, s[32:35], s37 offen offset:0 sc1
    ds_read_b64_tr_b16 a[78:79], v47 offset:2560
    ds_read_b64_tr_b16 a[80:81], v46 offset:4096
    ds_read_b64_tr_b16 a[82:83], v46 offset:4608
    buffer_load_dwordx4 a[188:191], v4, s[32:35], s37 offen offset:2048 sc1
    ds_read_b64_tr_b16 a[84:85], v47 offset:4096
    ds_read_b64_tr_b16 a[86:87], v47 offset:4608
    ds_read_b64_tr_b16 a[88:89], v46 offset:6144
    buffer_load_dwordx4 a[192:195], v4, s[32:35], s38 offen offset:0 sc1
    ds_read_b64_tr_b16 a[90:91], v46 offset:6656
    ds_read_b64_tr_b16 a[92:93], v47 offset:6144
    ds_read_b64_tr_b16 a[94:95], v47 offset:6656
    buffer_load_dwordx4 a[196:199], v4, s[32:35], s38 offen offset:2048 sc1
    ds_read_b64_tr_b16 a[96:97], v46 offset:32768
    ds_read_b64_tr_b16 a[98:99], v46 offset:33280
    ds_read_b64_tr_b16 a[100:101], v47 offset:32768
    buffer_load_dword v117, v115, s[16:19], 0 offen sc1
    ds_read_b64_tr_b16 a[102:103], v47 offset:33280
    ds_read_b64_tr_b16 a[104:105], v46 offset:34816
    ds_read_b64_tr_b16 a[106:107], v46 offset:35328
    buffer_load_dwordx4 a[200:203], v4, s[32:35], s39 offen offset:0 sc1
    ds_read_b64_tr_b16 a[108:109], v47 offset:34816
    ds_read_b64_tr_b16 a[110:111], v47 offset:35328
    ds_read_b64_tr_b16 a[112:113], v46 offset:36864
    buffer_load_dwordx4 a[204:207], v4, s[32:35], s39 offen offset:2048 sc1
    ds_read_b64_tr_b16 a[114:115], v46 offset:37376
    ds_read_b64_tr_b16 a[116:117], v47 offset:36864
    ds_read_b64_tr_b16 a[118:119], v47 offset:37376
    buffer_load_dwordx4 a[208:211], v4, s[32:35], s40 offen offset:0 sc1
    ds_read_b64_tr_b16 a[120:121], v46 offset:38912
    ds_read_b64_tr_b16 a[122:123], v46 offset:39424
    ds_read_b64_tr_b16 a[124:125], v47 offset:38912
    buffer_load_dwordx4 a[212:215], v4, s[32:35], s40 offen offset:2048 sc1
    ds_read_b64_tr_b16 a[126:127], v47 offset:39424
    s_waitcnt vmcnt(14)
    ds_read_b64_tr_b16 a[128:129], v44 offset:0
    ds_read_b64_tr_b16 a[130:131], v44 offset:512
    ds_read_b64_tr_b16 a[132:133], v45 offset:0
    ds_read_b64_tr_b16 a[134:135], v45 offset:512
    ds_read_b64_tr_b16 a[136:137], v44 offset:2048
    ds_read_b64_tr_b16 a[138:139], v44 offset:2560
    ds_read_b64_tr_b16 a[140:141], v45 offset:2048
    ds_read_b64_tr_b16 a[142:143], v45 offset:2560
    ds_read_b64_tr_b16 a[144:145], v44 offset:4096
    ds_read_b64_tr_b16 a[146:147], v44 offset:4608
    ds_read_b64_tr_b16 a[148:149], v45 offset:4096
    ds_read_b64_tr_b16 a[150:151], v45 offset:4608
    ds_read_b64_tr_b16 a[152:153], v44 offset:6144
    ds_read_b64_tr_b16 a[154:155], v44 offset:6656
    ds_read_b64_tr_b16 a[156:157], v45 offset:6144
    ds_read_b64_tr_b16 a[158:159], v45 offset:6656
    s_waitcnt vmcnt(10) lgkmcnt(0)
    v_mfma_f32_32x32x16_bf16 v[166:181], a[0:3], a[176:179], 0
    v_mfma_f32_32x32x16_bf16 v[182:197], a[4:7], a[176:179], 0
    buffer_load_dwordx4 a[216:219], v4, s[32:35], s41 offen offset:0 sc1
    s_waitcnt vmcnt(10)
    v_mfma_f32_32x32x16_bf16 v[166:181], a[8:11], a[180:183], v[166:181]
    v_mfma_f32_32x32x16_bf16 v[182:197], a[12:15], a[180:183], v[182:197]
    buffer_load_dwordx4 a[220:223], v4, s[32:35], s41 offen offset:2048 sc1
    s_waitcnt vmcnt(10)
    v_mfma_f32_32x32x16_bf16 v[166:181], a[16:19], a[184:187], v[166:181]
    v_mfma_f32_32x32x16_bf16 v[182:197], a[20:23], a[184:187], v[182:197]
    buffer_load_dwordx4 a[224:227], v4, s[32:35], s42 offen offset:0 sc1
    s_waitcnt vmcnt(10)
    v_mfma_f32_32x32x16_bf16 v[166:181], a[24:27], a[188:191], v[166:181]
    v_mfma_f32_32x32x16_bf16 v[182:197], a[28:31], a[188:191], v[182:197]
    buffer_load_dwordx4 a[228:231], v4, s[32:35], s42 offen offset:2048 sc1
    s_waitcnt vmcnt(10)
    v_mfma_f32_32x32x16_bf16 v[166:181], a[32:35], a[192:195], v[166:181]
    v_mfma_f32_32x32x16_bf16 v[182:197], a[36:39], a[192:195], v[182:197]
    buffer_load_dwordx4 a[232:235], v4, s[32:35], s43 offen offset:0 sc1
    s_waitcnt vmcnt(10)
    v_mfma_f32_32x32x16_bf16 v[166:181], a[40:43], a[196:199], v[166:181]
    v_mfma_f32_32x32x16_bf16 v[182:197], a[44:47], a[196:199], v[182:197]
    buffer_load_dwordx4 a[236:239], v4, s[32:35], s43 offen offset:2048 sc1
    s_waitcnt vmcnt(9)
    v_mfma_f32_32x32x16_bf16 v[166:181], a[48:51], a[200:203], v[166:181]
    s_cmp_eq_u32 s53, 0
    s_cselect_b32 s55, s50, 32505856
    s_waitcnt vmcnt(10)
    v_cmp_ne_u32 vcc, s79, v117
    s_cbranch_vccnz L_retryp3
L_backp3:
    s_barrier
    v_mfma_f32_32x32x16_bf16 v[182:197], a[52:55], a[200:203], v[182:197]
    buffer_load_dwordx4 a[176:179], v4, s[32:35], s44 offen offset:0 sc1
    s_add_u32 m0, s87, 139776
    s_nop 0
    buffer_load_dwordx4 v77, s[16:19], s10 offen offset:0 sc1 lds
    buffer_load_dwordx4 v77, s[16:19], s11 offen offset:1024 sc1 lds
    s_add_u32 s54, s55, 212992
    s_mov_b64 exec, 1
    buffer_store_dword v11, off, s[16:19], s54 sc1
    s_mov_b64 exec, -1
    s_waitcnt vmcnt(12)
    v_mfma_f32_32x32x16_bf16 v[166:181], a[56:59], a[204:207], v[166:181]
    v_mfma_f32_32x32x16_bf16 v[182:197], a[60:63], a[204:207], v[182:197]
    buffer_load_dwordx4 a[180:183], v4, s[32:35], s44 offen offset:2048 sc1
    s_waitcnt vmcnt(12)
    v_mfma_f32_32x32x16_bf16 v[166:181], a[64:67], a[208:211], v[166:181]
    v_mfma_f32_32x32x16_bf16 v[182:197], a[68:71], a[208:211], v[182:197]
    buffer_load_dwordx4 a[184:187], v4, s[32:35], s36 offen offset:1024 sc1
    s_waitcnt vmcnt(12)
    v_mfma_f32_32x32x16_bf16 v[166:181], a[72:75], a[212:215], v[166:181]
    v_mfma_f32_32x32x16_bf16 v[182:197], a[76:79], a[212:215], v[182:197]
    buffer_load_dwordx4 a[188:191], v4, s[32:35], s45 offen offset:0 sc1
    s_waitcnt vmcnt(12)
    v_mfma_f32_32x32x16_bf16 v[166:181], a[80:83], a[216:219], v[166:181]
    v_mfma_f32_32x32x16_bf16 v[182:197], a[84:87], a[216:219], v[182:197]
    buffer_load_dwordx4 a[192:195], v4, s[32:35], s36 offen offset:3072 sc1
    s_waitcnt vmcnt(12)
    v_mfma_f32_32x32x16_bf16 v[166:181], a[88:91], a[220:223], v[166:181]
    v_mfma_f32_32x32x16_bf16 v[182:197], a[92:95], a[220:223], v[182:197]
    buffer_load_dwordx4 a[196:199], v4, s[32:35], s45 offen offset:2048 sc1
    s_waitcnt vmcnt(12)
    v_mfma_f32_32x32x16_bf16 v[166:181], a[96:99], a[224:227], v[166:181]
    v_mfma_f32_32x32x16_bf16 v[182:197], a[100:103], a[224:227], v[182:197]
    buffer_load_dwordx4 a[200:203], v4, s[32:35], s37 offen offset:1024 sc1
    s_waitcnt vmcnt(12)
    v_mfma_f32_32x32x16_bf16 v[166:181], a[104:107], a[228:231], v[166:181]
    v_mfma_f32_32x32x16_bf16 v[182:197], a[108:111], a[228:231], v[182:197]
    buffer_load_dwordx4 a[204:207], v4, s[32:35], s46 offen offset:0 sc1
    s_waitcnt vmcnt(12)
    v_mfma_f32_32x32x16_bf16 v[166:181], a[112:115], a[232:235], v[166:181]
    v_mfma_f32_32x32x16_bf16 v[182:197], a[116:119], a[232:235], v[182:197]
    buffer_load_dwordx4 a[208:211], v4, s[32:35], s37 offen offset:3072 sc1
    s_waitcnt vmcnt(12)
    v_mfma_f32_32x32x16_bf16 v[166:181], a[120:123], a[236:239], v[166:181]
    v_mfma_f32_32x32x16_bf16 v[182:197], a[124:127], a[236:239], v[182:197]
    buffer_load_dwordx4 a[212:215], v4, s[32:35], s46 offen offset:2048 sc1
    s_waitcnt vmcnt(12)
    v_mfma_f32_32x32x16_bf16 v[166:181], a[128:131], a[176:179], v[166:181]
    v_mfma_f32_32x32x16_bf16 v[182:197], a[132:135], a[176:179], v[182:197]
    buffer_load_dwordx4 a[216:219], v4, s[32:35], s38 offen offset:1024 sc1
    s_waitcnt vmcnt(9)
    v_mfma_f32_32x32x16_bf16 v[166:181], a[136:139], a[180:183], v[166:181]
    v_mfma_f32_32x32x16_bf16 v[182:197], a[140:143], a[180:183], v[182:197]
    buffer_load_dwordx4 a[220:223], v4, s[32:35], s38 offen offset:3072 sc1
    s_waitcnt vmcnt(12)
    s_barrier
    ds_read_b64 v[36:37], v78 offset:0
    ds_read_b64 v[38:39], v78 offset:2048
    ds_read_b64 v[40:41], v78 offset:1024
    ds_read_b64 v[42:43], v78 offset:3072
    s_add_u32 m0, s62, 32768
    s_lshl3_add_u32 s56, s46, s24
    buffer_load_dwordx4 v72, s[12:15], s56 offen offset:0 lds
    buffer_load_dwordx4 v162, s[12:15], s56 offen offset:1024 lds
    s_waitcnt vmcnt(11)
    v_mfma_f32_32x32x16_bf16 v[198:213], a[0:3], a[184:187], 0
    v_mfma_f32_32x32x16_bf16 v[214:229], a[4:7], a[184:187], 0
    buffer_load_dwordx4 a[224:227], v4, s[32:35], s39 offen offset:1024 sc1
    s_waitcnt lgkmcnt(0)
    v_swap_b32 v37, v40
    v_swap_b32 v39, v42
    s_nop 1
    v_mfma_f32_16x16x32_bf16 v[52:55], v[60:63], v[36:39], 0
    v_mfma_f32_16x16x32_bf16 v[56:59], v[64:67], v[36:39], 0
    v_mfma_f32_16x16x32_bf16 v[84:87], v[60:63], v[40:43], 0
    v_mfma_f32_16x16x32_bf16 v[88:91], v[64:67], v[40:43], 0
    buffer_load_dwordx4 v163, s[12:15], s56 offen offset:2048 lds
    s_nop 4
    v_cvt_pk_bf16_f32 v36, v52, v56
    v_cvt_pk_bf16_f32 v37, v53, v57
    v_cvt_pk_bf16_f32 v38, v54, v58
    v_cvt_pk_bf16_f32 v39, v55, v59
    ds_write_b128 v79, v[36:39] offset:0
    v_cvt_pk_bf16_f32 v40, v84, v88
    v_cvt_pk_bf16_f32 v41, v85, v89
    v_cvt_pk_bf16_f32 v42, v86, v90
    v_cvt_pk_bf16_f32 v43, v87, v91
    ds_write_b128 v79, v[40:43] offset:16
    buffer_load_dwordx4 v164, s[12:15], s56 offen offset:3072 lds
    buffer_load_dwordx4 a[228:231], v4, s[32:35], s39 offen offset:3072 sc1
    s_waitcnt vmcnt(14)
    v_mfma_f32_32x32x16_bf16 v[166:181], a[144:147], a[188:191], v[166:181]
    v_mfma_f32_32x32x16_bf16 v[182:197], a[148:151], a[188:191], v[182:197]
    buffer_load_dwordx4 a[232:235], v4, s[32:35], s40 offen offset:1024 sc1
    s_waitcnt lgkmcnt(0)
    s_barrier
    ds_read_b64 v[36:37], v80
    ds_read_b64 v[38:39], v82
    ds_read_b64 v[40:41], v81
    ds_read_b64 v[42:43], v83
    buffer_load_dwordx4 a[236:239], v4, s[32:35], s40 offen offset:3072 sc1
    buffer_load_dwordx4 a[176:179], v4, s[32:35], s41 offen offset:1024 sc1
    s_waitcnt vmcnt(16)
    v_mfma_f32_32x32x16_bf16 v[198:213], a[8:11], a[192:195], v[198:213]
    v_mfma_f32_32x32x16_bf16 v[214:229], a[12:15], a[192:195], v[214:229]
    buffer_load_dwordx4 a[180:183], v4, s[32:35], s41 offen offset:3072 sc1
    s_waitcnt lgkmcnt(0)
    v_swap_b32 v37, v40
    v_swap_b32 v39, v42
    s_nop 1
    v_mfma_f32_16x16x32_bf16 v[52:55], v[36:39], v[104:107], 0
    v_mfma_f32_16x16x32_bf16 v[56:59], v[36:39], v[108:111], 0
    v_mfma_f32_16x16x32_bf16 v[92:95], v[36:39], a[248:251], 0
    v_mfma_f32_16x16x32_bf16 v[96:99], v[36:39], a[252:255], 0
    v_mfma_f32_16x16x32_bf16 v[84:87], v[40:43], v[104:107], 0
    v_mfma_f32_16x16x32_bf16 v[88:91], v[40:43], v[108:111], 0
    v_mfma_f32_16x16x32_bf16 v[120:123], v[40:43], a[248:251], 0
    v_mfma_f32_16x16x32_bf16 v[124:127], v[40:43], a[252:255], 0
    buffer_load_dwordx4 a[184:187], v4, s[32:35], s42 offen offset:1024 sc1
    s_nop 1
    v_cndmask_b32 v52, v52, v92, s[82:83]
    v_cndmask_b32 v56, v56, v96, s[82:83]
    v_pk_mul_f32 v[128:129], v[56:57], v[32:33]
    v_pk_mul_f32 v[130:131], v[52:53], v[32:33]
    v_pk_fma_f32 v[52:53], v[52:53], v[28:29], v[128:129] neg_lo:[0,0,1] neg_hi:[0,0,1]
    v_pk_fma_f32 v[56:57], v[56:57], v[28:29], v[130:131]
    v_pk_mul_f32 v[128:129], v[58:59], v[34:35]
    v_pk_mul_f32 v[130:131], v[54:55], v[34:35]
    v_pk_fma_f32 v[54:55], v[54:55], v[30:31], v[128:129] neg_lo:[0,0,1] neg_hi:[0,0,1]
    v_pk_fma_f32 v[58:59], v[58:59], v[30:31], v[130:131]
    v_cvt_pk_bf16_f32 v36, v52, v56
    v_cvt_pk_bf16_f32 v37, v53, v57
    v_cvt_pk_bf16_f32 v38, v54, v58
    v_cvt_pk_bf16_f32 v39, v55, v59
    v_cndmask_b32 v84, v84, v120, s[82:83]
    v_cndmask_b32 v88, v88, v124, s[82:83]
    v_mfma_f32_16x16x32_bf16 v[52:55], v[36:39], a[240:243], 0
    v_mfma_f32_16x16x32_bf16 v[56:59], v[36:39], a[244:247], 0
    v_pk_mul_f32 v[128:129], v[88:89], v[32:33]
    v_pk_mul_f32 v[130:131], v[84:85], v[32:33]
    v_pk_fma_f32 v[84:85], v[84:85], v[28:29], v[128:129] neg_lo:[0,0,1] neg_hi:[0,0,1]
    v_pk_fma_f32 v[88:89], v[88:89], v[28:29], v[130:131]
    v_pk_mul_f32 v[128:129], v[90:91], v[34:35]
    v_pk_mul_f32 v[130:131], v[86:87], v[34:35]
    v_pk_fma_f32 v[86:87], v[86:87], v[30:31], v[128:129] neg_lo:[0,0,1] neg_hi:[0,0,1]
    v_pk_fma_f32 v[90:91], v[90:91], v[30:31], v[130:131]
    v_cvt_pk_bf16_f32 v40, v84, v88
    v_cvt_pk_bf16_f32 v41, v85, v89
    v_cvt_pk_bf16_f32 v42, v86, v90
    v_cvt_pk_bf16_f32 v43, v87, v91
    v_cvt_pk_bf16_f32 v92, v52, v53
    v_cvt_pk_bf16_f32 v93, v54, v55
    v_mfma_f32_16x16x32_bf16 v[84:87], v[40:43], a[240:243], 0
    v_mfma_f32_16x16x32_bf16 v[88:91], v[40:43], a[244:247], 0
    v_cvt_pk_bf16_f32 v94, v56, v57
    v_cvt_pk_bf16_f32 v95, v58, v59
    buffer_load_dwordx4 a[188:191], v4, s[32:35], s42 offen offset:3072 sc1
    buffer_load_dwordx4 a[192:195], v4, s[32:35], s43 offen offset:1024 sc1
    v_min_u32 v92, -2, v92
    v_min_u32 v94, -2, v94
    v_min_u32 v93, -2, v93
    v_min_u32 v95, -2, v95
    v_permlane16_swap_b32 v92, v94
    s_nop 0
    v_permlane16_swap_b32 v93, v95
    buffer_store_dwordx4 v[92:95], v71, s[16:19], s48 offen sc1
    v_cvt_pk_bf16_f32 v120, v84, v85
    v_cvt_pk_bf16_f32 v121, v86, v87
    v_cvt_pk_bf16_f32 v122, v88, v89
    v_cvt_pk_bf16_f32 v123, v90, v91
    v_min_u32 v120, -2, v120
    v_min_u32 v122, -2, v122
    v_min_u32 v121, -2, v121
    v_min_u32 v123, -2, v123
    v_permlane16_swap_b32 v120, v122
    s_nop 0
    v_permlane16_swap_b32 v121, v123
    buffer_store_dwordx4 v[120:123], v71, s[16:19], s49 offen sc1
    s_waitcnt vmcnt(21)
    v_mfma_f32_32x32x16_bf16 v[166:181], a[152:155], a[196:199], v[166:181]
    s_waitcnt vmcnt(10)
    ds_read_b64_tr_b16 a[160:161], v44 offset:32768
    ds_read_b64_tr_b16 a[162:163], v44 offset:33280
    ds_read_b64_tr_b16 a[164:165], v45 offset:32768
    ds_read_b64_tr_b16 a[166:167], v45 offset:33280
    v_mfma_f32_32x32x16_bf16 v[182:197], a[156:159], a[196:199], v[182:197]
    buffer_load_dwordx4 a[196:199], v4, s[32:35], s43 offen offset:3072 sc1
    ds_read_b64_tr_b16 a[168:169], v44 offset:34816
    ds_read_b64_tr_b16 a[170:171], v44 offset:35328
    ds_read_b64_tr_b16 a[172:173], v45 offset:34816
    ds_read_b64_tr_b16 a[174:175], v45 offset:35328
    s_waitcnt vmcnt(21)
    v_mfma_f32_32x32x16_bf16 v[198:213], a[16:19], a[200:203], v[198:213]
    s_waitcnt vmcnt(48)
    v_mul_f32 v100, 0xbfb8aa3b, v48
    v_mul_f32 v102, 0xbfb8aa3b, v50
    v_lshlrev_b32 v28, 16, v12
    v_mfma_f32_32x32x16_bf16 v[214:229], a[20:23], a[200:203], v[214:229]
    buffer_load_dwordx4 a[200:203], v4, s[32:35], s44 offen offset:1024 sc1
    v_and_b32 v29, 0xffff0000, v12
    v_lshlrev_b32 v30, 16, v13
    v_and_b32 v31, 0xffff0000, v13
    v_lshlrev_b32 v32, 16, v14
    s_waitcnt vmcnt(21) lgkmcnt(0)
    v_mfma_f32_32x32x16_bf16 v[166:181], a[160:163], a[204:207], v[166:181]
    v_and_b32 v33, 0xffff0000, v14
    v_lshlrev_b32 v34, 16, v15
    v_and_b32 v35, 0xffff0000, v15
    v_lshlrev_b32 v36, 16, v16
    v_mfma_f32_32x32x16_bf16 v[182:197], a[164:167], a[204:207], v[182:197]
    buffer_load_dwordx4 a[204:207], v4, s[32:35], s44 offen offset:3072 sc1
    v_and_b32 v37, 0xffff0000, v16
    v_lshlrev_b32 v38, 16, v17
    v_and_b32 v39, 0xffff0000, v17
    v_lshlrev_b32 v40, 16, v18
    s_waitcnt vmcnt(21)
    v_mfma_f32_32x32x16_bf16 v[198:213], a[24:27], a[208:211], v[198:213]
    v_and_b32 v41, 0xffff0000, v18
    v_lshlrev_b32 v42, 16, v19
    v_mfma_f32_32x32x16_bf16 v[214:229], a[28:31], a[208:211], v[214:229]
    buffer_load_dwordx4 a[208:211], v4, s[32:35], s45 offen offset:1024 sc1
    v_and_b32 v43, 0xffff0000, v19
    s_waitcnt vmcnt(21)
    v_mfma_f32_32x32x16_bf16 v[166:181], a[168:171], a[212:215], v[166:181]
    v_mfma_f32_32x32x16_bf16 v[182:197], a[172:175], a[212:215], v[182:197]
    buffer_load_dwordx4 a[212:215], v4, s[32:35], s45 offen offset:3072 sc1
    s_waitcnt vmcnt(21)
    v_mfma_f32_32x32x16_bf16 v[198:213], a[32:35], a[216:219], v[198:213]
    v_mfma_f32_32x32x16_bf16 v[214:229], a[36:39], a[216:219], v[214:229]
    buffer_load_dwordx4 a[216:219], v4, s[32:35], s46 offen offset:1024 sc1
    s_waitcnt vmcnt(21)
    v_mfma_f32_32x32x16_bf16 v[198:213], a[40:43], a[220:223], v[198:213]
    s_nop 3
    ds_write_b128 v74, v[166:169] offset:0
    v_mfma_f32_32x32x16_bf16 v[214:229], a[44:47], a[220:223], v[214:229]
    buffer_load_dwordx4 a[220:223], v4, s[32:35], s46 offen offset:3072 sc1
    ds_write_b128 v74, v[170:173] offset:32
    s_waitcnt vmcnt(19)
    v_mfma_f32_32x32x16_bf16 v[198:213], a[48:51], a[224:227], v[198:213]
    ds_write_b128 v74, v[174:177] offset:64
    v_mfma_f32_32x32x16_bf16 v[214:229], a[52:55], a[224:227], v[214:229]
    ds_write_b128 v74, v[178:181] offset:96
    s_waitcnt vmcnt(16)
    v_mfma_f32_32x32x16_bf16 v[198:213], a[56:59], a[228:231], v[198:213]
    ds_write_b128 v74, v[182:185] offset:128
    v_mfma_f32_32x32x16_bf16 v[214:229], a[60:63], a[228:231], v[214:229]
    s_waitcnt vmcnt(15)
    v_mfma_f32_32x32x16_bf16 v[198:213], a[64:67], a[232:235], v[198:213]
    ds_write_b128 v74, v[186:189] offset:160
    v_mfma_f32_32x32x16_bf16 v[214:229], a[68:71], a[232:235], v[214:229]
    ds_write_b128 v74, v[190:193] offset:192
    s_waitcnt vmcnt(14)
    v_mfma_f32_32x32x16_bf16 v[198:213], a[72:75], a[236:239], v[198:213]
    ds_write_b128 v74, v[194:197] offset:224
    v_mfma_f32_32x32x16_bf16 v[214:229], a[76:79], a[236:239], v[214:229]
    s_waitcnt vmcnt(13)
    v_mfma_f32_32x32x16_bf16 v[198:213], a[80:83], a[176:179], v[198:213]
    v_mfma_f32_32x32x16_bf16 v[214:229], a[84:87], a[176:179], v[214:229]
    s_waitcnt vmcnt(12)
    v_mfma_f32_32x32x16_bf16 v[198:213], a[88:91], a[180:183], v[198:213]
    s_waitcnt lgkmcnt(0)
    s_barrier
    ds_read_b128 v[166:169], v75 offset:0
    ds_read_b128 v[170:173], v75 offset:16
    ds_read_b128 v[174:177], v75 offset:8704
    ds_read_b128 v[178:181], v75 offset:8720
    v_mfma_f32_32x32x16_bf16 v[214:229], a[92:95], a[180:183], v[214:229]
    ds_read_b128 v[182:185], v75 offset:17408
    ds_read_b128 v[186:189], v75 offset:17424
    ds_read_b128 v[190:193], v75 offset:26112
    ds_read_b128 v[194:197], v75 offset:26128
    s_waitcnt vmcnt(11)
    v_mfma_f32_32x32x16_bf16 v[198:213], a[96:99], a[184:187], v[198:213]
    buffer_load_dwordx4 v[20:23], v76, s[16:19], s8 offen sc1
    v_mfma_f32_32x32x16_bf16 v[214:229], a[100:103], a[184:187], v[214:229]
    buffer_load_dwordx4 v[24:27], v76, s[16:19], s9 offen sc1
    s_waitcnt vmcnt(12)
    v_mfma_f32_32x32x16_bf16 v[198:213], a[104:107], a[188:191], v[198:213]
    s_waitcnt lgkmcnt(0)
    v_add_f32 v166, v174, v166
    v_add_f32 v167, v175, v167
    v_add_f32 v168, v176, v168
    v_mfma_f32_32x32x16_bf16 v[214:229], a[108:111], a[188:191], v[214:229]
    v_add_f32 v169, v177, v169
    v_add_f32 v170, v178, v170
    v_add_f32 v171, v179, v171
    v_add_f32 v172, v180, v172
    s_waitcnt vmcnt(11)
    v_mfma_f32_32x32x16_bf16 v[198:213], a[112:115], a[192:195], v[198:213]
    v_add_f32 v173, v181, v173
    v_add_f32 v182, v190, v182
    v_add_f32 v183, v191, v183
    v_add_f32 v184, v192, v184
    v_mfma_f32_32x32x16_bf16 v[214:229], a[116:119], a[192:195], v[214:229]
    v_add_f32 v185, v193, v185
    v_add_f32 v186, v194, v186
    v_add_f32 v187, v195, v187
    v_add_f32 v188, v196, v188
    s_waitcnt vmcnt(8)
    v_mfma_f32_32x32x16_bf16 v[198:213], a[120:123], a[196:199], v[198:213]
    v_add_f32 v189, v197, v189
    v_add_f32 v166, v182, v166
    v_add_f32 v167, v183, v167
    v_add_f32 v168, v184, v168
    v_mfma_f32_32x32x16_bf16 v[214:229], a[124:127], a[196:199], v[214:229]
    v_add_f32 v169, v185, v169
    v_add_f32 v170, v186, v170
    v_add_f32 v171, v187, v171
    v_add_f32 v172, v188, v172
    s_waitcnt vmcnt(7)
    v_mfma_f32_32x32x16_bf16 v[198:213], a[128:131], a[200:203], v[198:213]
    v_add_f32 v173, v189, v173
    v_mul_f32 v174, v100, v166
    v_mul_f32 v175, v100, v167
    v_mul_f32 v176, v100, v168
    v_mfma_f32_32x32x16_bf16 v[214:229], a[132:135], a[200:203], v[214:229]
    v_mul_f32 v177, v100, v169
    v_mul_f32 v178, v100, v170
    v_mul_f32 v179, v100, v171
    v_mul_f32 v180, v100, v172
    s_waitcnt vmcnt(6)
    v_mfma_f32_32x32x16_bf16 v[198:213], a[136:139], a[204:207], v[198:213]
    v_mul_f32 v181, v100, v173
    v_exp_f32 v174, v174
    v_exp_f32 v175, v175
    v_exp_f32 v176, v176
    s_waitcnt vmcnt(5)
    v_mfma_f32_32x32x16_bf16 v[198:213], a[144:147], a[208:211], v[198:213]
    v_exp_f32 v177, v177
    v_exp_f32 v178, v178
    v_exp_f32 v179, v179
    v_exp_f32 v180, v180
    s_waitcnt vmcnt(4)
    v_mfma_f32_32x32x16_bf16 v[198:213], a[152:155], a[212:215], v[198:213]
    v_exp_f32 v181, v181
    v_mul_f32 v166, v48, v166
    v_mul_f32 v167, v48, v167
    v_mul_f32 v168, v48, v168
    s_waitcnt vmcnt(3)
    v_mfma_f32_32x32x16_bf16 v[198:213], a[160:163], a[216:219], v[198:213]
    v_mul_f32 v169, v48, v169
    v_mul_f32 v170, v48, v170
    v_mul_f32 v171, v48, v171
    v_mul_f32 v172, v48, v172
    s_waitcnt vmcnt(2)
    v_mfma_f32_32x32x16_bf16 v[198:213], a[168:171], a[220:223], v[198:213]
    v_mul_f32 v173, v48, v173
    v_add_f32 v174, 1.0, v174
    v_add_f32 v175, 1.0, v175
    v_add_f32 v176, 1.0, v176
    v_mfma_f32_32x32x16_bf16 v[214:229], a[140:143], a[204:207], v[214:229]
    v_add_f32 v177, 1.0, v177
    v_add_f32 v178, 1.0, v178
    v_add_f32 v179, 1.0, v179
    v_add_f32 v180, 1.0, v180
    v_mfma_f32_32x32x16_bf16 v[214:229], a[148:151], a[208:211], v[214:229]
    v_add_f32 v181, 1.0, v181
    v_rcp_f32 v174, v174
    v_rcp_f32 v175, v175
    v_rcp_f32 v176, v176
    v_mfma_f32_32x32x16_bf16 v[214:229], a[156:159], a[212:215], v[214:229]
    v_rcp_f32 v177, v177
    v_rcp_f32 v178, v178
    v_rcp_f32 v179, v179
    v_rcp_f32 v180, v180
    ds_write_b128 v74, v[198:201] offset:34816
    ds_write_b128 v74, v[202:205] offset:34848
    v_mfma_f32_32x32x16_bf16 v[214:229], a[164:167], a[216:219], v[214:229]
    v_rcp_f32 v181, v181
    v_mul_f32 v166, v174, v166
    v_mul_f32 v167, v175, v167
    v_mul_f32 v168, v176, v168
    ds_write_b128 v74, v[206:209] offset:34880
    ds_write_b128 v74, v[210:213] offset:34912
    v_mfma_f32_32x32x16_bf16 v[214:229], a[172:175], a[220:223], v[214:229]
    v_mul_f32 v169, v177, v169
    v_mul_f32 v170, v178, v170
    v_mul_f32 v171, v179, v171
    v_mul_f32 v172, v180, v172
    v_mul_f32 v173, v181, v173
    s_waitcnt vmcnt(0)
    v_max3_u32 v117, v20, v21, v22
    v_max3_u32 v8, v23, v24, v25
    v_max3_u32 v117, v117, v26, v27
    v_max_u32 v117, v117, v8
    v_cmp_eq_u32 vcc, -1, v117
    s_cbranch_vccnz L_retryS
L_backS:
    v_lshlrev_b32 v52, 16, v20
    v_and_b32 v53, 0xffff0000, v20
    v_lshlrev_b32 v54, 16, v21
    ds_write_b128 v74, v[214:217] offset:34944
    ds_write_b128 v74, v[218:221] offset:34976
    ds_write_b128 v74, v[222:225] offset:35008
    ds_write_b128 v74, v[226:229] offset:35040
    v_and_b32 v55, 0xffff0000, v21
    v_lshlrev_b32 v56, 16, v22
    v_and_b32 v57, 0xffff0000, v22
    v_lshlrev_b32 v58, 16, v23
    v_and_b32 v59, 0xffff0000, v23
    v_pk_fma_f32 v[166:167], v[166:167], v[52:53], v[28:29]
    v_pk_fma_f32 v[168:169], v[168:169], v[54:55], v[30:31]
    v_pk_fma_f32 v[170:171], v[170:171], v[56:57], v[32:33]
    v_pk_fma_f32 v[172:173], v[172:173], v[58:59], v[34:35]
    v_cvt_pk_bf16_f32 v182, v166, v167
    v_cvt_pk_bf16_f32 v183, v168, v169
    v_cvt_pk_bf16_f32 v184, v170, v171
    v_cvt_pk_bf16_f32 v185, v172, v173
    buffer_store_dwordx4 v[182:185], v76, s[28:31], s0 offen sc1
    v_lshlrev_b32 v60, 16, v24
    v_and_b32 v61, 0xffff0000, v24
    v_lshlrev_b32 v62, 16, v25
    v_and_b32 v63, 0xffff0000, v25
    v_lshlrev_b32 v64, 16, v26
    v_and_b32 v65, 0xffff0000, v26
    s_waitcnt lgkmcnt(0)
    s_barrier
    ds_read_b128 v[198:201], v75 offset:34816
    ds_read_b128 v[202:205], v75 offset:34832
    ds_read_b128 v[206:209], v75 offset:43520
    ds_read_b128 v[210:213], v75 offset:43536
    ds_read_b128 v[214:217], v75 offset:52224
    ds_read_b128 v[218:221], v75 offset:52240
    ds_read_b128 v[222:225], v75 offset:60928
    ds_read_b128 v[226:229], v75 offset:60944
    v_lshlrev_b32 v66, 16, v27
    v_and_b32 v67, 0xffff0000, v27
    v_pk_mul_f32 v[60:61], v[60:61], v[50:51] op_sel_hi:[1,0]
    v_pk_mul_f32 v[62:63], v[62:63], v[50:51] op_sel_hi:[1,0]
    v_pk_mul_f32 v[64:65], v[64:65], v[50:51] op_sel_hi:[1,0]
    v_pk_mul_f32 v[66:67], v[66:67], v[50:51] op_sel_hi:[1,0]
    s_waitcnt lgkmcnt(4)
    v_pk_add_f32 v[198:199], v[198:199], v[206:207]
    v_pk_add_f32 v[200:201], v[200:201], v[208:209]
    v_pk_add_f32 v[202:203], v[202:203], v[210:211]
    v_pk_add_f32 v[204:205], v[204:205], v[212:213]
    s_waitcnt lgkmcnt(0)
    v_pk_add_f32 v[214:215], v[214:215], v[222:223]
    v_pk_add_f32 v[216:217], v[216:217], v[224:225]
    v_pk_add_f32 v[218:219], v[218:219], v[226:227]
    v_pk_add_f32 v[220:221], v[220:221], v[228:229]
    v_pk_add_f32 v[198:199], v[198:199], v[214:215]
    v_pk_add_f32 v[200:201], v[200:201], v[216:217]
    v_pk_add_f32 v[202:203], v[202:203], v[218:219]
    v_pk_add_f32 v[204:205], v[204:205], v[220:221]
    v_pk_mul_f32 v[206:207], v[198:199], v[102:103] op_sel_hi:[1,0]
    v_pk_mul_f32 v[208:209], v[200:201], v[102:103] op_sel_hi:[1,0]
    v_pk_mul_f32 v[210:211], v[202:203], v[102:103] op_sel_hi:[1,0]
    v_pk_mul_f32 v[212:213], v[204:205], v[102:103] op_sel_hi:[1,0]
    v_exp_f32 v206, v206
    v_exp_f32 v207, v207
    v_exp_f32 v208, v208
    v_exp_f32 v209, v209
    v_exp_f32 v210, v210
    v_exp_f32 v211, v211
    v_exp_f32 v212, v212
    v_exp_f32 v213, v213
    v_pk_mul_f32 v[198:199], v[198:199], v[60:61]
    v_pk_mul_f32 v[200:201], v[200:201], v[62:63]
    v_pk_mul_f32 v[202:203], v[202:203], v[64:65]
    v_pk_mul_f32 v[204:205], v[204:205], v[66:67]
    v_pk_add_f32 v[206:207], v[206:207], 1.0 op_sel_hi:[1,0]
    v_pk_add_f32 v[208:209], v[208:209], 1.0 op_sel_hi:[1,0]
    v_pk_add_f32 v[210:211], v[210:211], 1.0 op_sel_hi:[1,0]
    v_pk_add_f32 v[212:213], v[212:213], 1.0 op_sel_hi:[1,0]
    v_rcp_f32 v206, v206
    v_rcp_f32 v207, v207
    v_rcp_f32 v208, v208
    v_rcp_f32 v209, v209
    v_rcp_f32 v210, v210
    v_rcp_f32 v211, v211
    v_rcp_f32 v212, v212
    v_rcp_f32 v213, v213
    v_pk_fma_f32 v[198:199], v[198:199], v[206:207], v[36:37]
    v_pk_fma_f32 v[200:201], v[200:201], v[208:209], v[38:39]
    v_pk_fma_f32 v[202:203], v[202:203], v[210:211], v[40:41]
    v_pk_fma_f32 v[204:205], v[204:205], v[212:213], v[42:43]
    v_cvt_pk_bf16_f32 v214, v198, v199
    v_cvt_pk_bf16_f32 v215, v200, v201
    v_cvt_pk_bf16_f32 v216, v202, v203
    v_cvt_pk_bf16_f32 v217, v204, v205
    buffer_store_dwordx4 v[214:217], v76, s[28:31], s1 offen sc1
L_end:
    s_endpgm
L_retryp1:
    s_add_u32 s61, s61, 1
    s_cmp_ge_u32 s61, 400000
    s_cbranch_scc1 L_outp1
    s_mov_b64 exec, vcc
    s_sleep 3
    buffer_load_dword v117, v115, s[16:19], 0 offen sc1
    s_waitcnt vmcnt(0)
    v_cmp_ne_u32 vcc, s79, v117
    s_cbranch_vccnz L_retryp1
L_outp1:
    s_mov_b64 exec, -1
    s_branch L_backp1
L_retryp3:
    s_add_u32 s61, s61, 1
    s_cmp_ge_u32 s61, 400000
    s_cbranch_scc1 L_outp3
    s_mov_b64 exec, vcc
    s_sleep 3
    buffer_load_dword v117, v115, s[16:19], 0 offen sc1
    s_waitcnt vmcnt(0)
    v_cmp_ne_u32 vcc, s79, v117
    s_cbranch_vccnz L_retryp3
L_outp3:
    s_mov_b64 exec, -1
    s_branch L_backp3
L_retryp2:
    s_add_u32 s61, s61, 1
    s_cmp_ge_u32 s61, 400000
    s_cbranch_scc1 L_outp2
    s_mov_b64 exec, vcc
    s_sleep 3
    buffer_load_dword v8, v116, s[16:19], 0 offen sc1
    s_waitcnt vmcnt(0)
    v_cmp_ne_u32 vcc, s79, v8
    s_cbranch_vccnz L_retryp2
L_outp2:
    s_mov_b64 exec, -1
    s_branch L_backp2
L_retryS:
    s_add_u32 s61, s61, 1
    s_cmp_ge_u32 s61, 400000
    s_cbranch_scc1 L_outS
    s_mov_b64 exec, vcc
    s_sleep 3
    buffer_load_dwordx4 v[20:23], v76, s[16:19], s8 offen sc1
    buffer_load_dwordx4 v[24:27], v76, s[16:19], s9 offen sc1
    s_waitcnt vmcnt(0)
    v_max3_u32 v117, v20, v21, v22
    v_max3_u32 v8, v23, v24, v25
    v_max3_u32 v117, v117, v26, v27
    v_max_u32 v117, v117, v8
    v_cmp_eq_u32 vcc, -1, v117
    s_cbranch_vccnz L_retryS
L_outS:
    s_mov_b64 exec, -1
    s_branch L_backS
L_codeend:
.section .rodata,"a"
.p2align 6
.amdhsa_kernel recurrent_scan__spectral_gfnet__dense_activation_relu__prompt_kernel
  .amdhsa_next_free_vgpr 512
  .amdhsa_next_free_sgpr 102
  .amdhsa_accum_offset 256
  .amdhsa_group_segment_fixed_size 0
  .amdhsa_kernarg_size 72
  .amdhsa_user_sgpr_count 2
  .amdhsa_user_sgpr_kernarg_segment_ptr 1
  .amdhsa_system_sgpr_workgroup_id_x 1
.end_amdhsa_kernel
.p2align 8
tbl:
.long 0x0,0x5d20,0xba00,0x0,0x10,0x5d30,0xba10,0x10
.long 0x20,0x5d00,0xba20,0x20,0x30,0x5d10,0xba30,0x30
.long 0x40,0x5d60,0xc440,0x40,0x50,0x5d70,0xc450,0x50
.long 0x60,0x5d40,0xc460,0x60,0x70,0x5d50,0xc470,0x70
.long 0x80,0x67a0,0xc480,0x202,0x90,0x67b0,0xc490,0x212
.long 0xa0,0x6780,0xc4a0,0x222,0xb0,0x6790,0xc4b0,0x232
.long 0xac0,0x67e0,0xc4c0,0x242,0xad0,0x67f0,0xc4d0,0x252
.long 0xae0,0x67c0,0xc4e0,0x262,0xaf0,0x67d0,0xc4f0,0x272
.long 0xb00,0x6820,0xfa20,0x404,0xb10,0x6830,0xfa30,0x414
.long 0xb20,0x6800,0xfa00,0x424,0xb30,0x6810,0xfa10,0x434
.long 0xb40,0x7260,0xfa60,0x444,0xb50,0x7270,0xfa70,0x454
.long 0xb60,0x7240,0xfa40,0x464,0xb70,0x7250,0xfa50,0x474
.long 0x1580,0x72a0,0xfaa0,0x606,0x1590,0x72b0,0xfab0,0x616
.long 0x15a0,0x7280,0xfa80,0x626,0x15b0,0x7290,0xfa90,0x636
.long 0x15c0,0x72e0,0x104e0,0x646,0x15d0,0x72f0,0x104f0,0x656
.long 0x15e0,0x72c0,0x104c0,0x666,0x15f0,0x72d0,0x104d0,0x676
.long 0x1600,0xa800,0x10520,0x808,0x1610,0xa810,0x10530,0x818
.long 0x1620,0xa820,0x10500,0x828,0x1630,0xa830,0x10510,0x838
.long 0x2040,0xa840,0x10560,0x848,0x2050,0xa850,0x10570,0x858
.long 0x2060,0xa860,0x10540,0x868,0x2070,0xa870,0x10550,0x878
.long 0x2080,0xa880,0x10fa0,0xa0a,0x2090,0xa890,0x10fb0,0xa1a
.long 0x20a0,0xa8a0,0x10f80,0xa2a,0x20b0,0xa8b0,0x10f90,0xa3a
.long 0x20c0,0xb2c0,0x10fe0,0xa4a,0x20d0,0xb2d0,0x10ff0,0xa5a
.long 0x20e0,0xb2e0,0x10fc0,0xa6a,0x20f0,0xb2f0,0x10fd0,0xa7a
.long 0x5620,0xb300,0x11020,0xc0c,0x5630,0xb310,0x11030,0xc1c
.long 0x5600,0xb320,0x11000,0xc2c,0x5610,0xb330,0x11010,0xc3c
.long 0x5660,0xb340,0x11a60,0xc4c,0x5670,0xb350,0x11a70,0xc5c
.long 0x5640,0xb360,0x11a40,0xc6c,0x5650,0xb370,0x11a50,0xc7c
.long 0x56a0,0xbd80,0x11aa0,0xe0e,0x56b0,0xbd90,0x11ab0,0xe1e
.long 0x5680,0xbda0,0x11a80,0xe2e,0x5690,0xbdb0,0x11a90,0xe3e
.long 0x60e0,0xbdc0,0x11ae0,0xe4e,0x60f0,0xbdd0,0x11af0,0xe5e
.long 0x60c0,0xbde0,0x11ac0,0xe6e,0x60d0,0xbdf0,0x11ad0,0xe7e
.long 0x3f803f80,0x3f803f80,0x3f803f80,0x3f803f80,0x3f7b3f80,0x3f553f6d,0xbf7bbf80,0xbf55bf6d
.long 0x3f6d3f80,0x3ec43f35,0x3f6d3f80,0x3ec43f35,0x3f553f80,0xbe483ec4,0xbf55bf80,0x3e48bec4
.long 0x3f353f80,0xbf350000,0x3f353f80,0xbf350000,0x3f0e3f80,0xbf7bbec4,0xbf0ebf80,0x3f7b3ec4
.long 0x3ec43f80,0xbf6dbf35,0x3ec43f80,0xbf6dbf35,0x3e483f80,0xbf0ebf6d,0xbe48bf80,0x3f0e3f6d
.long 0x3f80,0xbf80,0x3f80,0xbf80,0xbe483f80,0x3f0ebf6d,0x3e48bf80,0xbf0e3f6d
.long 0xbec43f80,0x3f6dbf35,0xbec43f80,0x3f6dbf35,0xbf0e3f80,0x3f7bbec4,0x3f0ebf80,0xbf7b3ec4
.long 0xbf353f80,0x3f350000,0xbf353f80,0x3f350000,0xbf553f80,0x3e483ec4,0x3f55bf80,0xbe48bec4
.long 0xbf6d3f80,0xbec43f35,0xbf6d3f80,0xbec43f35,0xbf7b3f80,0xbf553f6d,0x3f7bbf80,0x3f55bf6d
.long 0x3f803f80,0x3f803f80,0x3f803f80,0x3f803f80,0x3f0e3f35,0x3e483ec4,0xbf0ebf35,0xbe48bec4
.long 0xbec40000,0xbf6dbf35,0xbec40000,0xbf6dbf35,0xbf7bbf35,0xbf0ebf6d,0x3f7b3f35,0x3f0e3f6d
.long 0xbf35bf80,0x3f350000,0xbf35bf80,0x3f350000,0x3e48bf35,0x3f553f6d,0xbe483f35,0xbf55bf6d
.long 0x3f6d0000,0xbec43f35,0x3f6d0000,0xbec43f35,0x3f553f35,0xbf7bbec4,0xbf55bf35,0x3f7b3ec4
.long 0x3f80,0xbf80,0x3f80,0xbf80,0xbf553f35,0x3f7bbec4,0x3f55bf35,0xbf7b3ec4
.long 0xbf6d0000,0x3ec43f35,0xbf6d0000,0x3ec43f35,0xbe48bf35,0xbf553f6d,0x3e483f35,0x3f55bf6d
.long 0x3f35bf80,0xbf350000,0x3f35bf80,0xbf350000,0x3f7bbf35,0x3f0ebf6d,0xbf7b3f35,0xbf0e3f6d
.long 0x3ec40000,0x3f6dbf35,0x3ec40000,0x3f6dbf35,0xbf0e3f35,0xbe483ec4,0x3f0ebf35,0x3e48bec4
.long 0x3f803f80,0x3f803f80,0x3f803f80,0x3f803f80,0xbe480000,0xbf0ebec4,0x3e480000,0x3f0e3ec4
.long 0xbf6dbf80,0xbec4bf35,0xbf6dbf80,0xbec4bf35,0x3f0e0000,0x3f7b3f6d,0xbf0e0000,0xbf7bbf6d
.long 0x3f353f80,0xbf350000,0x3f353f80,0xbf350000,0xbf550000,0xbe48bf6d,0x3f550000,0x3e483f6d
.long 0xbec4bf80,0x3f6d3f35,0xbec4bf80,0x3f6d3f35,0x3f7b0000,0xbf553ec4,0xbf7b0000,0x3f55bec4
.long 0x3f80,0xbf80,0x3f80,0xbf80,0xbf7b0000,0x3f553ec4,0x3f7b0000,0xbf55bec4
.long 0x3ec4bf80,0xbf6d3f35,0x3ec4bf80,0xbf6d3f35,0x3f550000,0x3e48bf6d,0xbf550000,0xbe483f6d
.long 0xbf353f80,0x3f350000,0xbf353f80,0x3f350000,0xbf0e0000,0xbf7b3f6d,0x3f0e0000,0x3f7bbf6d
.long 0x3f6dbf80,0x3ec4bf35,0x3f6dbf80,0x3ec4bf35,0x3e480000,0x3f0ebec4,0xbe480000,0xbf0e3ec4
.long 0x3f803f80,0x3f803f80,0x3f803f80,0x3f803f80,0xbf55bf35,0xbf7bbf6d,0x3f553f35,0x3f7b3f6d
.long 0x3ec40000,0x3f6d3f35,0x3ec40000,0x3f6d3f35,0x3e483f35,0xbf55bec4,0xbe48bf35,0x3f553ec4
.long 0xbf35bf80,0x3f350000,0xbf35bf80,0x3f350000,0x3f7b3f35,0xbf0e3ec4,0xbf7bbf35,0x3f0ebec4
.long 0xbf6d0000,0x3ec4bf35,0xbf6d0000,0x3ec4bf35,0x3f0ebf35,0xbe483f6d,0xbf0e3f35,0x3e48bf6d
.long 0x3f80,0xbf80,0x3f80,0xbf80,0xbf0ebf35,0x3e483f6d,0x3f0e3f35,0xbe48bf6d
.long 0x3f6d0000,0xbec4bf35,0x3f6d0000,0xbec4bf35,0xbf7b3f35,0x3f0e3ec4,0x3f7bbf35,0xbf0ebec4
.long 0x3f35bf80,0xbf350000,0x3f35bf80,0xbf350000,0xbe483f35,0x3f55bec4,0x3e48bf35,0xbf553ec4
.long 0xbec40000,0xbf6d3f35,0xbec40000,0xbf6d3f35,0x3f55bf35,0x3f7bbf6d,0xbf553f35,0xbf7b3f6d
.long 0xbf803f80,0xbf803f80,0xbf803f80,0xbf803f80,0xbe488000,0xbf0ebec4,0x3e488000,0x3f0e3ec4
.long 0xbec48000,0xbf6dbf35,0xbec48000,0xbf6dbf35,0xbf0e8000,0xbf7bbf6d,0x3f0e8000,0x3f7b3f6d
.long 0xbf358000,0xbf35bf80,0xbf358000,0xbf35bf80,0xbf558000,0xbe48bf6d,0x3f558000,0x3e483f6d
.long 0xbf6d8000,0x3ec4bf35,0xbf6d8000,0x3ec4bf35,0xbf7b8000,0x3f55bec4,0x3f7b8000,0xbf553ec4
.long 0xbf808000,0x3f808000,0xbf808000,0x3f808000,0xbf7b8000,0x3f553ec4,0x3f7b8000,0xbf55bec4
.long 0xbf6d8000,0x3ec43f35,0xbf6d8000,0x3ec43f35,0xbf558000,0xbe483f6d,0x3f558000,0x3e48bf6d
.long 0xbf358000,0xbf353f80,0xbf358000,0xbf353f80,0xbf0e8000,0xbf7b3f6d,0x3f0e8000,0x3f7bbf6d
.long 0xbec48000,0xbf6d3f35,0xbec48000,0xbf6d3f35,0xbe488000,0xbf0e3ec4,0x3e488000,0x3f0ebec4
.long 0xbf803f80,0xbf803f80,0xbf803f80,0xbf803f80,0xbf55bf35,0xbf7bbf6d,0x3f553f35,0x3f7b3f6d
.long 0xbf6dbf80,0xbec4bf35,0xbf6dbf80,0xbec4bf35,0xbe48bf35,0x3f553ec4,0x3e483f35,0xbf55bec4
.long 0x3f358000,0x3f353f80,0x3f358000,0x3f353f80,0x3f7b3f35,0xbf0e3ec4,0xbf7bbf35,0x3f0ebec4
.long 0x3ec43f80,0xbf6dbf35,0x3ec43f80,0xbf6dbf35,0xbf0e3f35,0x3e48bf6d,0x3f0ebf35,0xbe483f6d
.long 0xbf808000,0x3f808000,0xbf808000,0x3f808000,0xbf0ebf35,0x3e483f6d,0x3f0e3f35,0xbe48bf6d
.long 0x3ec4bf80,0xbf6d3f35,0x3ec4bf80,0xbf6d3f35,0x3f7bbf35,0xbf0ebec4,0xbf7b3f35,0x3f0e3ec4
.long 0x3f358000,0x3f35bf80,0x3f358000,0x3f35bf80,0xbe483f35,0x3f55bec4,0x3e48bf35,0xbf553ec4
.long 0xbf6d3f80,0xbec43f35,0xbf6d3f80,0xbec43f35,0xbf553f35,0xbf7b3f6d,0x3f55bf35,0x3f7bbf6d
.long 0xbf803f80,0xbf803f80,0xbf803f80,0xbf803f80,0xbf7bbf80,0xbf55bf6d,0x3f7b3f80,0x3f553f6d
.long 0x3ec48000,0x3f6d3f35,0x3ec48000,0x3f6d3f35,0x3f553f80,0xbe483ec4,0xbf55bf80,0x3e48bec4
.long 0xbf358000,0xbf35bf80,0xbf358000,0xbf35bf80,0xbf0ebf80,0x3f7b3ec4,0x3f0e3f80,0xbf7bbec4
.long 0x3f6d8000,0xbec43f35,0x3f6d8000,0xbec43f35,0x3e483f80,0xbf0ebf6d,0xbe48bf80,0x3f0e3f6d
.long 0xbf808000,0x3f808000,0xbf808000,0x3f808000,0x3e48bf80,0xbf0e3f6d,0xbe483f80,0x3f0ebf6d
.long 0x3f6d8000,0xbec4bf35,0x3f6d8000,0xbec4bf35,0xbf0e3f80,0x3f7bbec4,0x3f0ebf80,0xbf7b3ec4
.long 0xbf358000,0xbf353f80,0xbf358000,0xbf353f80,0x3f55bf80,0xbe48bec4,0xbf553f80,0x3e483ec4
.long 0x3ec48000,0x3f6dbf35,0x3ec48000,0x3f6dbf35,0xbf7b3f80,0xbf553f6d,0x3f7bbf80,0x3f55bf6d
.long 0xbf803f80,0xbf803f80,0xbf803f80,0xbf803f80,0xbf0ebf35,0xbe48bec4,0x3f0e3f35,0x3e483ec4
.long 0x3f6d3f80,0x3ec43f35,0x3f6d3f80,0x3ec43f35,0xbf7bbf35,0xbf0ebf6d,0x3f7b3f35,0x3f0e3f6d
.long 0x3f358000,0x3f353f80,0x3f358000,0x3f353f80,0xbe483f35,0xbf55bf6d,0x3e48bf35,0x3f553f6d
.long 0xbec4bf80,0x3f6d3f35,0xbec4bf80,0x3f6d3f35,0x3f553f35,0xbf7bbec4,0xbf55bf35,0x3f7b3ec4
.long 0xbf808000,0x3f808000,0xbf808000,0x3f808000,0x3f55bf35,0xbf7b3ec4,0xbf553f35,0x3f7bbec4
.long 0xbec43f80,0x3f6dbf35,0xbec43f80,0x3f6dbf35,0xbe48bf35,0xbf553f6d,0x3e483f35,0x3f55bf6d
.long 0x3f358000,0x3f35bf80,0x3f358000,0x3f35bf80,0xbf7b3f35,0xbf0e3f6d,0x3f7bbf35,0x3f0ebf6d
.long 0x3f6dbf80,0x3ec4bf35,0x3f6dbf80,0x3ec4bf35,0xbf0e3f35,0xbe483ec4,0x3f0ebf35,0x3e48bec4
.long 0x3f80,0x22200,0x3f800000,0x3f800000,0x3f80,0x22208,0x0,0x3f800000
.long 0x3f80,0x22210,0x0,0x3f800000,0x3f80,0x22218,0x0,0x3f800000
.long 0x3f80,0x22220,0x0,0x3f800000,0x3f80,0x22228,0x0,0x3f800000
.long 0x3f80,0x22230,0x0,0x3f800000,0x3f80,0x22238,0x0,0x3f800000
.long 0x3f80,0x22240,0x0,0xbf800000,0x3f80,0x22248,0x0,0xbf800000
.long 0x3f80,0x22250,0x0,0xbf800000,0x3f80,0x22258,0x0,0xbf800000
.long 0x3f80,0x22260,0x0,0xbf800000,0x3f80,0x22268,0x0,0xbf800000
.long 0x3f80,0x22270,0x0,0xbf800000,0x3f80,0x22278,0x0,0xbf800000
.long 0x3f80,0x22280,0x3f800000,0x3f800000,0x3f80,0x22288,0x0,0x3f800000
.long 0x3f80,0x22290,0x0,0x3f800000,0x3f80,0x22298,0x0,0x3f800000
.long 0x3f80,0x222a0,0x0,0x3f800000,0x3f80,0x222a8,0x0,0x3f800000
.long 0x3f80,0x222b0,0x0,0x3f800000,0x3f80,0x222b8,0x0,0x3f800000
.long 0x3f80,0x222c0,0x0,0xbf800000,0x3f80,0x222c8,0x0,0xbf800000
.long 0x3f80,0x222d0,0x0,0xbf800000,0x3f80,0x222d8,0x0,0xbf800000
.long 0x3f80,0x222e0,0x0,0xbf800000,0x3f80,0x222e8,0x0,0xbf800000
.long 0x3f80,0x222f0,0x0,0xbf800000,0x3f80,0x222f8,0x0,0xbf800000
.long 0x3f80,0x22300,0x3f800000,0x3f800000,0x3f80,0x22308,0x0,0x3f800000
.long 0x3f80,0x22310,0x0,0x3f800000,0x3f80,0x22318,0x0,0x3f800000
.long 0x3f80,0x22320,0x0,0x3f800000,0x3f80,0x22328,0x0,0x3f800000
.long 0x3f80,0x22330,0x0,0x3f800000,0x3f80,0x22338,0x0,0x3f800000
.long 0x3f80,0x22340,0x0,0xbf800000,0x3f80,0x22348,0x0,0xbf800000
.long 0x3f80,0x22350,0x0,0xbf800000,0x3f80,0x22358,0x0,0xbf800000
.long 0x3f80,0x22360,0x0,0xbf800000,0x3f80,0x22368,0x0,0xbf800000
.long 0x3f80,0x22370,0x0,0xbf800000,0x3f80,0x22378,0x0,0xbf800000
.long 0x3f80,0x22380,0x3f800000,0x3f800000,0x3f80,0x22388,0x0,0x3f800000
.long 0x3f80,0x22390,0x0,0x3f800000,0x3f80,0x22398,0x0,0x3f800000
.long 0x3f80,0x223a0,0x0,0x3f800000,0x3f80,0x223a8,0x0,0x3f800000
.long 0x3f80,0x223b0,0x0,0x3f800000,0x3f80,0x223b8,0x0,0x3f800000
.long 0x3f80,0x223c0,0x0,0xbf800000,0x3f80,0x223c8,0x0,0xbf800000
.long 0x3f80,0x223d0,0x0,0xbf800000,0x3f80,0x223d8,0x0,0xbf800000
.long 0x3f80,0x223e0,0x0,0xbf800000,0x3f80,0x223e8,0x0,0xbf800000
.long 0x3f80,0x223f0,0x0,0xbf800000,0x3f80,0x223f8,0x0,0xbf800000
.long 0x3f800000,0x3f800000,0x3f800000,0x3f800000,0x3f800000,0x3f7ffb11,0x3f7fec43,0x3f7fd397
.long 0x3f800000,0x3f7fec43,0x3f7fb10f,0x3f7f4e6d,0x3f800000,0x3f7fd397,0x3f7f4e6d,0x3f7e70b0
.long 0x3f800000,0x3f7fb10f,0x3f7ec46d,0x3f7d3aac,0x3f800000,0x3f7f84ab,0x3f7e1324,0x3f7baccd
.long 0x3f800000,0x3f7f4e6d,0x3f7d3aac,0x3f79c79d,0x3f800000,0x3f7f0e58,0x3f7c3b28,0x3f778bc5
.long 0x3f800000,0x3f7ec46d,0x3f7b14be,0x3f74fa0b,0x3f800000,0x3f7e70b0,0x3f79c79d,0x3f721352
.long 0x3f800000,0x3f7e1324,0x3f7853f8,0x3f6ed89e,0x3f800000,0x3f7dabcc,0x3f76ba07,0x3f6b4b0c
.long 0x3f800000,0x3f7d3aac,0x3f74fa0b,0x3f676bd8,0x3f800000,0x3f7cbfc9,0x3f731447,0x3f633c5a
.long 0x3f800000,0x3f7c3b28,0x3f710908,0x3f5ebe05,0x3f800000,0x3f7baccd,0x3f6ed89e,0x3f59f26a
.long 0x3f800000,0x3f800000,0x3f800000,0x3f800000,0x3f7fb10f,0x3f7f84ab,0x3f7f4e6d,0x3f7f0e58
.long 0x3f7ec46d,0x3f7e1324,0x3f7d3aac,0x3f7c3b28,0x3f7d3aac,0x3f7baccd,0x3f79c79d,0x3f778bc5
.long 0x3f7b14be,0x3f7853f8,0x3f74fa0b,0x3f710908,0x3f7853f8,0x3f740bdd,0x3f6ed89e,0x3f68bf3c
.long 0x3f74fa0b,0x3f6ed89e,0x3f676bd8,0x3f5ebe05,0x3f710908,0x3f68bf3c,0x3f5ebe05,0x3f531849
.long 0x3f6c835e,0x3f61c598,0x3f54db31,0x3f45e403,0x3f676bd8,0x3f59f26a,0x3f49d112,0x3f373a23
.long 0x3f61c598,0x3f514d3d,0x3f3daef9,0x3f273656,0x3f5b941a,0x3f47de65,0x3f3085bb,0x3f15f6d9
.long 0x3f54db31,0x3f3daef9,0x3f226799,0x3f039c3d,0x3f4d9f02,0x3f32c8c9,0x3f13682a,0x3ee0924f
.long 0x3f45e403,0x3f273656,0x3f039c3d,0x3eb8442a,0x3f3daef9,0x3f1b02c6,0x3ee63375,0x3e8e9a22
.long 0x3f800000,0x3f800000,0x3f800000,0x3f800000,0x3f7ec46d,0x3f7e70b0,0x3f7e1324,0x3f7dabcc
.long 0x3f7b14be,0x3f79c79d,0x3f7853f8,0x3f76ba07,0x3f74fa0b,0x3f721352,0x3f6ed89e,0x3f6b4b0c
.long 0x3f6c835e,0x3f676bd8,0x3f61c598,0x3f5b941a,0x3f61c598,0x3f59f26a,0x3f514d3d,0x3f47de65
.long 0x3f54db31,0x3f49d112,0x3f3daef9,0x3f3085bb,0x3f45e403,0x3f373a23,0x3f273656,0x3f15f6d9
.long 0x3f3504f3,0x3f226799,0x3f0e39da,0x3ef15aea,0x3f226799,0x3f0b9a6b,0x3ee63375,0x3eb263ef
.long 0x3f0e39da,0x3ee63375,0x3eac7cd4,0x3e605c13,0x3ef15aea,0x3eb263ef,0x3e605c13,0x3dafb680
.long 0x3ec3ef15,0x3e78cfcc,0x3dc8bd36,0xbd48fb30,0x3e94a031,0x3e09cf86,0xbcc90ab0,0xbe3b6ecf
.long 0x3e47c5c2,0x3cc90ab0,0xbe164083,0xbea09ae5,0x3dc8bd36,0xbdafb680,0xbe888e93,0xbee0924f
.long 0x3f800000,0x3f800000,0x3f800000,0x3f800000,0x3f7d3aac,0x3f7cbfc9,0x3f7c3b28,0x3f7baccd
.long 0x3f74fa0b,0x3f731447,0x3f710908,0x3f6ed89e,0x3f676bd8,0x3f633c5a,0x3f5ebe05,0x3f59f26a
.long 0x3f54db31,0x3f4d9f02,0x3f45e403,0x3f3daef9,0x3f3daef9,0x3f32c8c9,0x3f273656,0x3f1b02c6
.long 0x3f226799,0x3f13682a,0x3f039c3d,0x3ee63375,0x3f039c3d,0x3ee0924f,0x3eb8442a,0x3e8e9a22
.long 0x3ec3ef15,0x3e94a031,0x3e47c5c2,0x3dc8bd36,0x3e78cfcc,0x3e09cf86,0x3cc90ab0,0xbdafb680
.long 0x3dc8bd36,0xbcc90ab0,0xbe164083,0xbe888e93,0xbd48fb30,0xbe3b6ecf,0xbea09ae5,0xbee0924f
.long 0xbe47c5c2,0xbeac7cd4,0xbef15aea,0xbf187fc0,0xbeac7cd4,0xbef6e0cb,0xbf1d7fd1,0xbf3b8f3b
.long 0xbef15aea,0xbf1d7fd1,0xbf3daef9,0xbf584853,0xbf187fc0,0xbf3b8f3b,0xbf584853,0xbf6db293
.long 0x0,0x0,0x0,0x0,0x0,0x3c490e90,0x3cc90ab0,0x3d16c32c
.long 0x0,0x3cc90ab0,0x3d48fb30,0x3d96a905,0x0,0x3d16c32c,0x3d96a905,0x3de1bc2e
.long 0x0,0x3d48fb30,0x3dc8bd36,0x3e164083,0x0,0x3d7b2b74,0x3dfab273,0x3e3b6ecf
.long 0x0,0x3d96a905,0x3e164083,0x3e605c13,0x0,0x3dafb680,0x3e2f10a2,0x3e827dc0
.long 0x0,0x3dc8bd36,0x3e47c5c2,0x3e94a031,0x0,0x3de1bc2e,0x3e605c13,0x3ea68f12
.long 0x0,0x3dfab273,0x3e78cfcc,0x3eb8442a,0x0,0x3e09cf86,0x3e888e93,0x3ec9b953
.long 0x0,0x3e164083,0x3e94a031,0x3edae880,0x0,0x3e22abb6,0x3ea09ae5,0x3eebcbbb
.long 0x0,0x3e2f10a2,0x3eac7cd4,0x3efc5d27,0x0,0x3e3b6ecf,0x3eb8442a,0x3f064b82
.long 0x0,0x0,0x0,0x0,0x3d48fb30,0x3d7b2b74,0x3d96a905,0x3dafb680
.long 0x3dc8bd36,0x3dfab273,0x3e164083,0x3e2f10a2,0x3e164083,0x3e3b6ecf,0x3e605c13,0x3e827dc0
.long 0x3e47c5c2,0x3e78cfcc,0x3e94a031,0x3eac7cd4,0x3e78cfcc,0x3e9aa086,0x3eb8442a,0x3ed53641
.long 0x3e94a031,0x3eb8442a,0x3edae880,0x3efc5d27,0x3eac7cd4,0x3ed53641,0x3efc5d27,0x3f10d3cd
.long 0x3ec3ef15,0x3ef15aea,0x3f0e39da,0x3f226799,0x3edae880,0x3f064b82,0x3f1d7fd1,0x3f32c8c9
.long 0x3ef15aea,0x3f13682a,0x3f2beb4a,0x3f41d870,0x3f039c3d,0x3f1ff6cb,0x3f396842,0x3f4f7a1f
.long 0x3f0e39da,0x3f2beb4a,0x3f45e403,0x3f5b941a,0x3f187fc0,0x3f373a23,0x3f514d3d,0x3f660f88
.long 0x3f226799,0x3f41d870,0x3f5b941a,0x3f6ed89e,0x3f2beb4a,0x3f4bbbf8,0x3f64aa59,0x3f75dec6
.long 0x0,0x0,0x0,0x0,0x3dc8bd36,0x3de1bc2e,0x3dfab273,0x3e09cf86
.long 0x3e47c5c2,0x3e605c13,0x3e78cfcc,0x3e888e93,0x3e94a031,0x3ea68f12,0x3eb8442a,0x3ec9b953
.long 0x3ec3ef15,0x3edae880,0x3ef15aea,0x3f039c3d,0x3ef15aea,0x3f064b82,0x3f13682a,0x3f1ff6cb
.long 0x3f0e39da,0x3f1d7fd1,0x3f2beb4a,0x3f396842,0x3f226799,0x3f32c8c9,0x3f41d870,0x3f4f7a1f
.long 0x3f3504f3,0x3f45e403,0x3f54db31,0x3f61c598,0x3f45e403,0x3f5695e5,0x3f64aa59,0x3f6ff573
.long 0x3f54db31,0x3f64aa59,0x3f710908,0x3f79c79d,0x3f61c598,0x3f6ff573,0x3f79c79d,0x3f7f0e58
.long 0x3f6c835e,0x3f7853f8,0x3f7ec46d,0x3f7fb10f,0x3f74fa0b,0x3f7dabcc,0x3f7fec43,0x3f7baccd
.long 0x3f7b14be,0x3f7fec43,0x3f7d3aac,0x3f731447,0x3f7ec46d,0x3f7f0e58,0x3f76ba07,0x3f660f88
.long 0x0,0x0,0x0,0x0,0x3e164083,0x3e22abb6,0x3e2f10a2,0x3e3b6ecf
.long 0x3e94a031,0x3ea09ae5,0x3eac7cd4,0x3eb8442a,0x3edae880,0x3eebcbbb,0x3efc5d27,0x3f064b82
.long 0x3f0e39da,0x3f187fc0,0x3f226799,0x3f2beb4a,0x3f2beb4a,0x3f373a23,0x3f41d870,0x3f4bbbf8
.long 0x3f45e403,0x3f514d3d,0x3f5b941a,0x3f64aa59,0x3f5b941a,0x3f660f88,0x3f6ed89e,0x3f75dec6
.long 0x3f6c835e,0x3f74fa0b,0x3f7b14be,0x3f7ec46d,0x3f7853f8,0x3f7dabcc,0x3f7fec43,0x3f7f0e58
.long 0x3f7ec46d,0x3f7fec43,0x3f7d3aac,0x3f76ba07,0x3f7fb10f,0x3f7baccd,0x3f731447,0x3f660f88
.long 0x3f7b14be,0x3f710908,0x3f61c598,0x3f4d9f02,0x3f710908,0x3f604621,0x3f49d112,0x3f2e3bde
.long 0x3f61c598,0x3f49d112,0x3f2beb4a,0x3f08f59b,0x3f4d9f02,0x3f2e3bde,0x3f08f59b,0x3ebe1d4a
.long 0x3f80,0x3f80,0x3f80,0x3f80,0x3f80,0x3ec43f6d,0x3f353f35,0x3f6d3ec4
.long 0x3f80,0x3f353f35,0x3f800000,0x3f35bf35,0x3f80,0x3f6d3ec4,0x3f35bf35,0xbec4bf6d
.long 0x3f80,0x3f800000,0xbf80,0xbf800000,0x3f80,0x3f6dbec4,0xbf35bf35,0xbec43f6d
.long 0x3f80,0x3f35bf35,0xbf800000,0x3f353f35,0x3f80,0x3ec4bf6d,0xbf353f35,0x3f6dbec4
.long 0x3f80,0xbf80,0x3f80,0xbf80,0x3f80,0xbec4bf6d,0x3f353f35,0xbf6dbec4
.long 0x3f80,0xbf35bf35,0x3f800000,0xbf353f35,0x3f80,0xbf6dbec4,0x3f35bf35,0x3ec43f6d
.long 0x3f80,0xbf800000,0xbf80,0x3f800000,0x3f80,0xbf6d3ec4,0xbf35bf35,0x3ec4bf6d
.long 0x3f80,0xbf353f35,0xbf800000,0xbf35bf35,0x3f80,0xbec43f6d,0xbf353f35,0xbf6d3ec4
.long 0x3f80,0x3f80,0x3f80,0x3f80,0x3f800000,0x3f6dbec4,0x3f35bf35,0x3ec4bf6d
.long 0xbf80,0xbf35bf35,0xbf800000,0xbf353f35,0xbf800000,0xbec43f6d,0x3f353f35,0x3f6dbec4
.long 0x3f80,0x3f800000,0xbf80,0xbf800000,0x3f800000,0xbec4bf6d,0xbf353f35,0x3f6d3ec4
.long 0xbf80,0xbf353f35,0x3f800000,0xbf35bf35,0xbf800000,0x3f6d3ec4,0xbf35bf35,0x3ec43f6d
.long 0x3f80,0xbf80,0x3f80,0xbf80,0x3f800000,0xbf6d3ec4,0x3f35bf35,0xbec43f6d
.long 0xbf80,0x3f353f35,0xbf800000,0x3f35bf35,0xbf800000,0x3ec4bf6d,0x3f353f35,0xbf6d3ec4
.long 0x3f80,0xbf800000,0xbf80,0x3f800000,0x3f800000,0x3ec43f6d,0xbf353f35,0xbf6dbec4
.long 0xbf80,0x3f35bf35,0x3f800000,0x3f353f35,0xbf800000,0xbf6dbec4,0xbf35bf35,0xbec4bf6d
.long 0x3f80,0x3f80,0x3f80,0x3f80,0xbf80,0xbec4bf6d,0xbf35bf35,0xbf6dbec4
.long 0x3f80,0x3f353f35,0x3f800000,0x3f35bf35,0xbf80,0xbf6dbec4,0xbf353f35,0x3ec43f6d
.long 0x3f80,0x3f800000,0xbf80,0xbf800000,0xbf80,0xbf6d3ec4,0x3f353f35,0x3ec4bf6d
.long 0x3f80,0x3f35bf35,0xbf800000,0x3f353f35,0xbf80,0xbec43f6d,0x3f35bf35,0xbf6d3ec4
.long 0x3f80,0xbf80,0x3f80,0xbf80,0xbf80,0x3ec43f6d,0xbf35bf35,0x3f6d3ec4
.long 0x3f80,0xbf35bf35,0x3f800000,0xbf353f35,0xbf80,0x3f6d3ec4,0xbf353f35,0xbec4bf6d
.long 0x3f80,0xbf800000,0xbf80,0x3f800000,0xbf80,0x3f6dbec4,0x3f353f35,0xbec43f6d
.long 0x3f80,0xbf353f35,0xbf800000,0xbf35bf35,0xbf80,0x3ec4bf6d,0x3f35bf35,0x3f6dbec4
.long 0x3f80,0x3f80,0x3f80,0x3f80,0xbf800000,0xbf6d3ec4,0xbf353f35,0xbec43f6d
.long 0xbf80,0xbf35bf35,0xbf800000,0xbf353f35,0x3f800000,0x3ec4bf6d,0xbf35bf35,0xbf6d3ec4
.long 0x3f80,0x3f800000,0xbf80,0xbf800000,0xbf800000,0x3ec43f6d,0x3f35bf35,0xbf6dbec4
.long 0xbf80,0xbf353f35,0x3f800000,0xbf35bf35,0x3f800000,0xbf6dbec4,0x3f353f35,0xbec4bf6d
.long 0x3f80,0xbf80,0x3f80,0xbf80,0xbf800000,0x3f6dbec4,0xbf353f35,0x3ec4bf6d
.long 0xbf80,0x3f353f35,0xbf800000,0x3f35bf35,0x3f800000,0xbec43f6d,0xbf35bf35,0x3f6dbec4
.long 0x3f80,0xbf800000,0xbf80,0x3f800000,0xbf800000,0xbec4bf6d,0x3f35bf35,0x3f6d3ec4
.long 0xbf80,0x3f35bf35,0x3f800000,0x3f353f35,0x3f800000,0x3f6d3ec4,0x3f353f35,0x3ec43f6d
.long 0x3f808000,0x3f808000,0x3f808000,0x3f808000,0x3f808000,0x3f6dbec4,0x3f35bf35,0x3ec4bf6d
.long 0x3f808000,0x3f35bf35,0xbf80,0xbf35bf35,0x3f808000,0x3ec4bf6d,0xbf35bf35,0xbf6d3ec4
.long 0x3f808000,0xbf80,0xbf808000,0x3f80,0x3f808000,0xbec4bf6d,0xbf353f35,0x3f6d3ec4
.long 0x3f808000,0xbf35bf35,0x3f80,0x3f35bf35,0x3f808000,0xbf6dbec4,0x3f353f35,0xbec4bf6d
.long 0x3f808000,0xbf808000,0x3f808000,0xbf808000,0x3f808000,0xbf6d3ec4,0x3f35bf35,0xbec43f6d
.long 0x3f808000,0xbf353f35,0xbf80,0x3f353f35,0x3f808000,0xbec43f6d,0xbf35bf35,0x3f6dbec4
.long 0x3f808000,0x3f80,0xbf808000,0xbf80,0x3f808000,0x3ec43f6d,0xbf353f35,0xbf6dbec4
.long 0x3f808000,0x3f353f35,0x3f80,0xbf353f35,0x3f808000,0x3f6d3ec4,0x3f353f35,0x3ec43f6d
.long 0x3f808000,0x3f808000,0x3f808000,0x3f808000,0xbf80,0xbec4bf6d,0xbf35bf35,0xbf6dbec4
.long 0xbf808000,0xbf353f35,0x3f80,0x3f353f35,0x3f80,0x3f6d3ec4,0x3f35bf35,0xbec4bf6d
.long 0x3f808000,0xbf80,0xbf808000,0x3f80,0xbf80,0xbf6d3ec4,0x3f353f35,0x3ec4bf6d
.long 0xbf808000,0x3f353f35,0xbf80,0xbf353f35,0x3f80,0x3ec4bf6d,0xbf353f35,0x3f6dbec4
.long 0x3f808000,0xbf808000,0x3f808000,0xbf808000,0xbf80,0x3ec43f6d,0xbf35bf35,0x3f6d3ec4
.long 0xbf808000,0x3f35bf35,0x3f80,0xbf35bf35,0x3f80,0xbf6dbec4,0x3f35bf35,0x3ec43f6d
.long 0x3f808000,0x3f80,0xbf808000,0xbf80,0xbf80,0x3f6dbec4,0x3f353f35,0xbec43f6d
.long 0xbf808000,0xbf35bf35,0xbf80,0x3f35bf35,0x3f80,0xbec43f6d,0xbf353f35,0xbf6d3ec4
.long 0x3f808000,0x3f808000,0x3f808000,0x3f808000,0xbf808000,0xbf6d3ec4,0xbf353f35,0xbec43f6d
.long 0x3f808000,0x3f35bf35,0xbf80,0xbf35bf35,0xbf808000,0xbec43f6d,0x3f353f35,0x3f6dbec4
.long 0x3f808000,0xbf80,0xbf808000,0x3f80,0xbf808000,0x3ec43f6d,0x3f35bf35,0xbf6dbec4
.long 0x3f808000,0xbf35bf35,0x3f80,0x3f35bf35,0xbf808000,0x3f6d3ec4,0xbf35bf35,0x3ec43f6d
.long 0x3f808000,0xbf808000,0x3f808000,0xbf808000,0xbf808000,0x3f6dbec4,0xbf353f35,0x3ec4bf6d
.long 0x3f808000,0xbf353f35,0xbf80,0x3f353f35,0xbf808000,0x3ec4bf6d,0x3f353f35,0xbf6d3ec4
.long 0x3f808000,0x3f80,0xbf808000,0xbf80,0xbf808000,0xbec4bf6d,0x3f35bf35,0x3f6d3ec4
.long 0x3f808000,0x3f353f35,0x3f80,0xbf353f35,0xbf808000,0xbf6dbec4,0xbf35bf35,0xbec4bf6d
.long 0x3f808000,0x3f808000,0x3f808000,0x3f808000,0x3f80,0x3ec43f6d,0x3f353f35,0x3f6d3ec4
.long 0xbf808000,0xbf353f35,0x3f80,0x3f353f35,0xbf80,0xbf6dbec4,0xbf353f35,0x3ec43f6d
.long 0x3f808000,0xbf80,0xbf808000,0x3f80,0x3f80,0x3f6dbec4,0xbf35bf35,0xbec43f6d
.long 0xbf808000,0x3f353f35,0xbf80,0xbf353f35,0xbf80,0xbec43f6d,0x3f35bf35,0xbf6d3ec4
.long 0x3f808000,0xbf808000,0x3f808000,0xbf808000,0x3f80,0xbec4bf6d,0x3f353f35,0xbf6dbec4
.long 0xbf808000,0x3f35bf35,0x3f80,0xbf35bf35,0xbf80,0x3f6d3ec4,0xbf353f35,0xbec4bf6d
.long 0x3f808000,0x3f80,0xbf808000,0xbf80,0x3f80,0xbf6d3ec4,0xbf35bf35,0x3ec4bf6d
.long 0xbf808000,0xbf35bf35,0xbf80,0x3f35bf35,0xbf80,0x3ec4bf6d,0x3f35bf35,0x3f6dbec4
.long 0x3f80,0xbf80,0x3f80,0xbf80,0x3f80,0x3f6d,0x3f35,0x3ec4
.long 0x3f80,0x3f35,0x0,0xbf35,0x3f80,0x3ec4,0xbf35,0xbf6d
.long 0x3f80,0x0,0xbf80,0x0,0x3f80,0xbec4,0xbf35,0x3f6d
.long 0x3f80,0xbf35,0x0,0x3f35,0x3f80,0xbf6d,0x3f35,0xbec4
.long 0x3f800000,0xbf7b0000,0x3f6d0000,0xbf550000,0x3f800000,0xbf550000,0x3ec40000,0x3e480000
.long 0x3f800000,0xbf0e0000,0xbec40000,0x3f7b0000,0x3f800000,0xbe480000,0xbf6d0000,0x3f0e0000
.long 0x3f800000,0x3e480000,0xbf6d0000,0xbf0e0000,0x3f800000,0x3f0e0000,0xbec40000,0xbf7b0000
.long 0x3f800000,0x3f550000,0x3ec40000,0xbe480000,0x3f800000,0x3f7b0000,0x3f6d0000,0x3f550000
.long 0x3f80,0xbf80,0x3f80,0xbf80,0x0,0xbec4,0xbf35,0xbf6d
.long 0xbf80,0xbf35,0x0,0x3f35,0x0,0x3f6d,0x3f35,0xbec4
.long 0x3f80,0x0,0xbf80,0x0,0x0,0xbf6d,0x3f35,0x3ec4
.long 0xbf80,0x3f35,0x0,0xbf35,0x0,0x3ec4,0xbf35,0x3f6d
.long 0x3f350000,0xbf0e0000,0x3ec40000,0xbe480000,0xbf350000,0x3f7b0000,0xbf6d0000,0x3f0e0000
.long 0xbf350000,0xbe480000,0x3f6d0000,0xbf550000,0x3f350000,0xbf550000,0xbec40000,0x3f7b0000
.long 0x3f350000,0x3f550000,0xbec40000,0xbf7b0000,0xbf350000,0x3e480000,0x3f6d0000,0x3f550000
.long 0xbf350000,0xbf7b0000,0xbf6d0000,0xbf0e0000,0x3f350000,0x3f0e0000,0x3ec40000,0x3e480000
.long 0x3f80,0xbf80,0x3f80,0xbf80,0xbf80,0xbf6d,0xbf35,0xbec4
.long 0x3f80,0x3f35,0x0,0xbf35,0xbf80,0xbec4,0x3f35,0x3f6d
.long 0x3f80,0x0,0xbf80,0x0,0xbf80,0x3ec4,0x3f35,0xbf6d
.long 0x3f80,0xbf35,0x0,0x3f35,0xbf80,0x3f6d,0xbf35,0x3ec4
.long 0x0,0x3e480000,0xbec40000,0x3f0e0000,0x0,0xbf0e0000,0x3f6d0000,0xbf7b0000
.long 0x0,0x3f550000,0xbf6d0000,0x3e480000,0x0,0xbf7b0000,0x3ec40000,0x3f550000
.long 0x0,0x3f7b0000,0x3ec40000,0xbf550000,0x0,0xbf550000,0xbf6d0000,0xbe480000
.long 0x0,0x3f0e0000,0x3f6d0000,0x3f7b0000,0x0,0xbe480000,0xbec40000,0xbf0e0000
.long 0x3f80,0xbf80,0x3f80,0xbf80,0x0,0x3ec4,0x3f35,0x3f6d
.long 0xbf80,0xbf35,0x0,0x3f35,0x0,0xbf6d,0xbf35,0x3ec4
.long 0x3f80,0x0,0xbf80,0x0,0x0,0x3f6d,0xbf35,0xbec4
.long 0xbf80,0x3f35,0x0,0xbf35,0x0,0xbec4,0x3f35,0xbf6d
.long 0xbf350000,0x3f550000,0xbf6d0000,0x3f7b0000,0x3f350000,0xbe480000,0xbec40000,0x3f550000
.long 0x3f350000,0xbf7b0000,0x3ec40000,0x3f0e0000,0xbf350000,0xbf0e0000,0x3f6d0000,0x3e480000
.long 0xbf350000,0x3f0e0000,0x3f6d0000,0xbe480000,0x3f350000,0x3f7b0000,0x3ec40000,0xbf0e0000
.long 0x3f350000,0x3e480000,0xbec40000,0xbf550000,0xbf350000,0xbf550000,0xbf6d0000,0xbf7b0000
.long 0x8000,0x8000,0x8000,0x8000,0x8000,0xbec4,0xbf35,0xbf6d
.long 0x8000,0xbf35,0xbf80,0xbf35,0x8000,0xbf6d,0xbf35,0x3ec4
.long 0x8000,0xbf80,0x8000,0x3f80,0x8000,0xbf6d,0x3f35,0x3ec4
.long 0x8000,0xbf35,0x3f80,0xbf35,0x8000,0xbec4,0x3f35,0xbf6d
.long 0x80000000,0x3e480000,0xbec40000,0x3f0e0000,0x80000000,0x3f0e0000,0xbf6d0000,0x3f7b0000
.long 0x80000000,0x3f550000,0xbf6d0000,0x3e480000,0x80000000,0x3f7b0000,0xbec40000,0xbf550000
.long 0x80000000,0x3f7b0000,0x3ec40000,0xbf550000,0x80000000,0x3f550000,0x3f6d0000,0x3e480000
.long 0x80000000,0x3f0e0000,0x3f6d0000,0x3f7b0000,0x80000000,0x3e480000,0x3ec40000,0x3f0e0000
.long 0x8000,0x8000,0x8000,0x8000,0xbf80,0xbf6d,0xbf35,0xbec4
.long 0x8000,0x3f35,0x3f80,0x3f35,0x3f80,0x3ec4,0xbf35,0xbf6d
.long 0x8000,0xbf80,0x8000,0x3f80,0xbf80,0x3ec4,0x3f35,0xbf6d
.long 0x8000,0x3f35,0xbf80,0x3f35,0x3f80,0xbf6d,0x3f35,0xbec4
.long 0xbf350000,0x3f550000,0xbf6d0000,0x3f7b0000,0xbf350000,0x3e480000,0x3ec40000,0xbf550000
.long 0x3f350000,0xbf7b0000,0x3ec40000,0x3f0e0000,0x3f350000,0x3f0e0000,0xbf6d0000,0xbe480000
.long 0xbf350000,0x3f0e0000,0x3f6d0000,0xbe480000,0xbf350000,0xbf7b0000,0xbec40000,0x3f0e0000
.long 0x3f350000,0x3e480000,0xbec40000,0xbf550000,0x3f350000,0x3f550000,0x3f6d0000,0x3f7b0000
.long 0x8000,0x8000,0x8000,0x8000,0x8000,0x3ec4,0x3f35,0x3f6d
.long 0x8000,0xbf35,0xbf80,0xbf35,0x8000,0x3f6d,0x3f35,0xbec4
.long 0x8000,0xbf80,0x8000,0x3f80,0x8000,0x3f6d,0xbf35,0xbec4
.long 0x8000,0xbf35,0x3f80,0xbf35,0x8000,0x3ec4,0xbf35,0x3f6d
.long 0xbf800000,0x3f7b0000,0xbf6d0000,0x3f550000,0x3f800000,0xbf550000,0x3ec40000,0x3e480000
.long 0xbf800000,0x3f0e0000,0x3ec40000,0xbf7b0000,0x3f800000,0xbe480000,0xbf6d0000,0x3f0e0000
.long 0xbf800000,0xbe480000,0x3f6d0000,0x3f0e0000,0x3f800000,0x3f0e0000,0xbec40000,0xbf7b0000
.long 0xbf800000,0xbf550000,0xbec40000,0x3e480000,0x3f800000,0x3f7b0000,0x3f6d0000,0x3f550000
.long 0x8000,0x8000,0x8000,0x8000,0x3f80,0x3f6d,0x3f35,0x3ec4
.long 0x8000,0x3f35,0x3f80,0x3f35,0xbf80,0xbec4,0x3f35,0x3f6d
.long 0x8000,0xbf80,0x8000,0x3f80,0x3f80,0xbec4,0xbf35,0x3f6d
.long 0x8000,0x3f35,0xbf80,0x3f35,0xbf80,0x3f6d,0xbf35,0x3ec4
.long 0xbf350000,0x3f0e0000,0xbec40000,0x3e480000,0xbf350000,0x3f7b0000,0xbf6d0000,0x3f0e0000
.long 0x3f350000,0x3e480000,0xbf6d0000,0x3f550000,0x3f350000,0xbf550000,0xbec40000,0x3f7b0000
.long 0xbf350000,0xbf550000,0x3ec40000,0x3f7b0000,0xbf350000,0x3e480000,0x3f6d0000,0x3f550000
.long 0x3f350000,0x3f7b0000,0x3f6d0000,0x3f0e0000,0x3f350000,0x3f0e0000,0x3ec40000,0x3e480000
.long 0x21060,0x20000,0x20010,0x20020,0x201f0,0x20210,0x20220,0x20230
.long 0x20400,0x20420,0x20430,0x20440,0x20610,0x20630,0x20640,0x20650
.long 0x20820,0x20840,0x20850,0x20860,0x20a30,0x20a50,0x20a60,0x20a70
.long 0x20c40,0x20c60,0x20c70,0x20c80,0x20e50,0x20e70,0x20e80,0x20e90
.long 0x20f60,0x21050,0x21040,0x21030,0x20d50,0x20e40,0x20e30,0x20e20
.long 0x20b40,0x20c30,0x20c20,0x20c10,0x20930,0x20a20,0x20a10,0x20a00
.long 0x20720,0x20810,0x20800,0x207f0,0x20510,0x20600,0x205f0,0x205e0
.long 0x20300,0x203f0,0x203e0,0x203d0,0x200f0,0x201e0,0x201d0,0x201c0
.long 0x20030,0x20040,0x20050,0x20060,0x20240,0x20250,0x20260,0x20270
.long 0x20450,0x20460,0x20470,0x20480,0x20660,0x20670,0x20680,0x20690
.long 0x20870,0x20880,0x20890,0x208a0,0x20a80,0x20a90,0x20aa0,0x20ab0
.long 0x20c90,0x20ca0,0x20cb0,0x20cc0,0x20ea0,0x20eb0,0x20ec0,0x20ed0
.long 0x21020,0x21010,0x21000,0x20ff0,0x20e10,0x20e00,0x20df0,0x20de0
.long 0x20c00,0x20bf0,0x20be0,0x20bd0,0x209f0,0x209e0,0x209d0,0x209c0
.long 0x207e0,0x207d0,0x207c0,0x207b0,0x205d0,0x205c0,0x205b0,0x205a0
.long 0x203c0,0x203b0,0x203a0,0x20390,0x201b0,0x201a0,0x20190,0x20180
.long 0x20070,0x20080,0x20090,0x200a0,0x20280,0x20290,0x202a0,0x202b0
.long 0x20490,0x204a0,0x204b0,0x204c0,0x206a0,0x206b0,0x206c0,0x206d0
.long 0x208b0,0x208c0,0x208d0,0x208e0,0x20ac0,0x20ad0,0x20ae0,0x20af0
.long 0x20cd0,0x20ce0,0x20cf0,0x20d00,0x20ee0,0x20ef0,0x20f00,0x20f10
.long 0x20fe0,0x20fd0,0x20fc0,0x20fb0,0x20dd0,0x20dc0,0x20db0,0x20da0
.long 0x20bc0,0x20bb0,0x20ba0,0x20b90,0x209b0,0x209a0,0x20990,0x20980
.long 0x207a0,0x20790,0x20780,0x20770,0x20590,0x20580,0x20570,0x20560
.long 0x20380,0x20370,0x20360,0x20350,0x20170,0x20160,0x20150,0x20140
.long 0x200b0,0x200c0,0x200d0,0x200e0,0x202c0,0x202d0,0x202e0,0x202f0
.long 0x204d0,0x204e0,0x204f0,0x20500,0x206e0,0x206f0,0x20700,0x20710
.long 0x208f0,0x20900,0x20910,0x20920,0x20b00,0x20b10,0x20b20,0x20b30
.long 0x20d10,0x20d20,0x20d30,0x20d40,0x20f20,0x20f30,0x20f40,0x20f50
.long 0x20fa0,0x20f90,0x20f80,0x20f70,0x20d90,0x20d80,0x20d70,0x20d60
.long 0x20b80,0x20b70,0x20b60,0x20b50,0x20970,0x20960,0x20950,0x20940
.long 0x20760,0x20750,0x20740,0x20730,0x20550,0x20540,0x20530,0x20520
.long 0x20340,0x20330,0x20320,0x20310,0x20130,0x20120,0x20110,0x20100
.long 0x22230,0x22220,0x22200,0x22320,0x22270,0x22260,0x22210,0x22330
.long 0x222a0,0x222b0,0x22420,0x22540,0x222e0,0x222f0,0x22430,0x22550
.long 0x22310,0x22300,0x22640,0x22760,0x22350,0x22340,0x22650,0x22770
.long 0x22380,0x22390,0x22860,0x22980,0x223c0,0x223d0,0x22870,0x22990
.long 0x22450,0x22440,0x22a80,0x22ba0,0x22490,0x22480,0x22a90,0x22bb0
.long 0x224c0,0x224d0,0x22ca0,0x22dc0,0x22500,0x22510,0x22cb0,0x22dd0
.long 0x22530,0x22520,0x22ec0,0x22fe0,0x22570,0x22560,0x22ed0,0x22ff0
.long 0x225a0,0x225b0,0x230e0,0x23200,0x225e0,0x225f0,0x230f0,0x23210
.long 0x22670,0x22660,0x22240,0x22360,0x226b0,0x226a0,0x22250,0x22370
.long 0x226e0,0x226f0,0x22460,0x22580,0x22720,0x22730,0x22470,0x22590
.long 0x22750,0x22740,0x22680,0x227a0,0x22790,0x22780,0x22690,0x227b0
.long 0x227c0,0x227d0,0x228a0,0x229c0,0x22800,0x22810,0x228b0,0x229d0
.long 0x22890,0x22880,0x22ac0,0x22be0,0x228d0,0x228c0,0x22ad0,0x22bf0
.long 0x22900,0x22910,0x22ce0,0x22e00,0x22940,0x22950,0x22cf0,0x22e10
.long 0x22970,0x22960,0x22f00,0x23020,0x229b0,0x229a0,0x22f10,0x23030
.long 0x229e0,0x229f0,0x23120,0x23240,0x22a20,0x22a30,0x23130,0x23250
.long 0x22ab0,0x22aa0,0x22290,0x223b0,0x22af0,0x22ae0,0x22280,0x223a0
.long 0x22b20,0x22b30,0x224b0,0x225d0,0x22b60,0x22b70,0x224a0,0x225c0
.long 0x22b90,0x22b80,0x226d0,0x227f0,0x22bd0,0x22bc0,0x226c0,0x227e0
.long 0x22c00,0x22c10,0x228f0,0x22a10,0x22c40,0x22c50,0x228e0,0x22a00
.long 0x22cd0,0x22cc0,0x22b10,0x22c30,0x22d10,0x22d00,0x22b00,0x22c20
.long 0x22d40,0x22d50,0x22d30,0x22e50,0x22d80,0x22d90,0x22d20,0x22e40
.long 0x22db0,0x22da0,0x22f50,0x23070,0x22df0,0x22de0,0x22f40,0x23060
.long 0x22e20,0x22e30,0x23170,0x23290,0x22e60,0x22e70,0x23160,0x23280
.long 0x22ef0,0x22ee0,0x222d0,0x223f0,0x22f30,0x22f20,0x222c0,0x223e0
.long 0x22f60,0x22f70,0x224f0,0x22610,0x22fa0,0x22fb0,0x224e0,0x22600
.long 0x22fd0,0x22fc0,0x22710,0x22830,0x23010,0x23000,0x22700,0x22820
.long 0x23040,0x23050,0x22930,0x22a50,0x23080,0x23090,0x22920,0x22a40
.long 0x23110,0x23100,0x22b50,0x22c70,0x23150,0x23140,0x22b40,0x22c60
.long 0x23180,0x23190,0x22d70,0x22e90,0x231c0,0x231d0,0x22d60,0x22e80
.long 0x231f0,0x231e0,0x22f90,0x230b0,0x23230,0x23220,0x22f80,0x230a0
.long 0x23260,0x23270,0x231b0,0x232d0,0x232a0,0x232b0,0x231a0,0x232c0
.long 0x20000,0x22200,0x0,0xe20000,0x20010,0x22210,0x10,0xe20020
.long 0x20020,0x22220,0x20,0xe20000,0x20030,0x22230,0x30,0xe20020
.long 0x20080,0x22240,0x40,0xe20000,0x20090,0x22250,0x50,0xe20020
.long 0x200a0,0x22260,0x60,0xe20000,0x200b0,0x22270,0x70,0xe20020
.long 0x20100,0x22280,0x90,0xe20000,0x20110,0x22290,0x80,0xe20020
.long 0x20120,0x222a0,0xb0,0xe20000,0x20130,0x222b0,0xa0,0xe20020
.long 0x20180,0x222c0,0xd0,0xe20000,0x20190,0x222d0,0xc0,0xe20020
.long 0x201a0,0x222e0,0xf0,0xe20000,0x201b0,0x222f0,0xe0,0xe20020
.long 0x210c0,0x22300,0x120,0xe20000,0x210d0,0x22310,0x130,0xe20020
.long 0x210e0,0x22320,0x100,0xe20000,0x210f0,0x22330,0x110,0xe20020
.long 0x21140,0x22340,0x160,0xe20000,0x21150,0x22350,0x170,0xe20020
.long 0x21160,0x22360,0x140,0xe20000,0x21170,0x22370,0x150,0xe20020
.long 0x211c0,0x22380,0x1b0,0xe20000,0x211d0,0x22390,0x1a0,0xe20020
.long 0x211e0,0x223a0,0x190,0xe20000,0x211f0,0x223b0,0x180,0xe20020
.long 0x21240,0x223c0,0x1f0,0xe20000,0x21250,0x223d0,0x1e0,0xe20020
.long 0x21260,0x223e0,0x1d0,0xe20000,0x21270,0x223f0,0x1c0,0xe20020
.long 0x20040,0x22420,0x800,0xe20010,0x20050,0x22430,0x810,0xe20030
.long 0x20060,0x22440,0x820,0xe20010,0x20070,0x22450,0x830,0xe20030
.long 0x200c0,0x22460,0x840,0xe20010,0x200d0,0x22470,0x850,0xe20030
.long 0x200e0,0x22480,0x860,0xe20010,0x200f0,0x22490,0x870,0xe20030
.long 0x20140,0x224a0,0x890,0xe20010,0x20150,0x224b0,0x880,0xe20030
.long 0x20160,0x224c0,0x8b0,0xe20010,0x20170,0x224d0,0x8a0,0xe20030
.long 0x201c0,0x224e0,0x8d0,0xe20010,0x201d0,0x224f0,0x8c0,0xe20030
.long 0x201e0,0x22500,0x8f0,0xe20010,0x201f0,0x22510,0x8e0,0xe20030
.long 0x21100,0x22520,0x920,0xe20010,0x21110,0x22530,0x930,0xe20030
.long 0x21120,0x22540,0x900,0xe20010,0x21130,0x22550,0x910,0xe20030
.long 0x21180,0x22560,0x960,0xe20010,0x21190,0x22570,0x970,0xe20030
.long 0x211a0,0x22580,0x940,0xe20010,0x211b0,0x22590,0x950,0xe20030
.long 0x21200,0x225a0,0x9b0,0xe20010,0x21210,0x225b0,0x9a0,0xe20030
.long 0x21220,0x225c0,0x990,0xe20010,0x21230,0x225d0,0x980,0xe20030
.long 0x21280,0x225e0,0x9f0,0xe20010,0x21290,0x225f0,0x9e0,0xe20030
.long 0x212a0,0x22600,0x9d0,0xe20010,0x212b0,0x22610,0x9c0,0xe20030
.long 0x0,0x1000,0xe20020,0x0,0x8,0x1080,0xe20120,0x10
.long 0x10,0x1110,0xe20220,0x20,0x18,0x1190,0xe20320,0x30
.long 0xc0,0x1220,0xe20420,0x4000,0xc8,0x12a0,0xe20520,0x4010
.long 0xd0,0x1330,0xe20620,0x4020,0xd8,0x13b0,0xe20720,0x4030
.long 0x180,0x1440,0xe20030,0x8000,0x188,0x14c0,0xe20130,0x8010
.long 0x190,0x1550,0xe20230,0x8020,0x198,0x15d0,0xe20330,0x8030
.long 0x240,0x1660,0xe20430,0xc000,0x248,0x16e0,0xe20530,0xc010
.long 0x250,0x1770,0xe20630,0xc020,0x258,0x17f0,0xe20730,0xc030
.long 0x320,0x1010,0xe20020,0x10010,0x328,0x1090,0xe20120,0x10000
.long 0x330,0x1100,0xe20220,0x10030,0x338,0x1180,0xe20320,0x10020
.long 0x3e0,0x1230,0xe20420,0x14010,0x3e8,0x12b0,0xe20520,0x14000
.long 0x3f0,0x1320,0xe20620,0x14030,0x3f8,0x13a0,0xe20720,0x14020
.long 0x4a0,0x1450,0xe20030,0x18010,0x4a8,0x14d0,0xe20130,0x18000
.long 0x4b0,0x1540,0xe20230,0x18030,0x4b8,0x15c0,0xe20330,0x18020
.long 0x560,0x1670,0xe20430,0x1c010,0x568,0x16f0,0xe20530,0x1c000
.long 0x570,0x1760,0xe20630,0x1c030,0x578,0x17e0,0xe20730,0x1c020
.long 0x600,0x1020,0xe20020,0x20020,0x608,0x10a0,0xe20120,0x20030
.long 0x610,0x1130,0xe20220,0x20000,0x618,0x11b0,0xe20320,0x20010
.long 0x6c0,0x1200,0xe20420,0x24020,0x6c8,0x1280,0xe20520,0x24030
.long 0x6d0,0x1310,0xe20620,0x24000,0x6d8,0x1390,0xe20720,0x24010
.long 0x780,0x1460,0xe20030,0x28020,0x788,0x14e0,0xe20130,0x28030
.long 0x790,0x1570,0xe20230,0x28000,0x798,0x15f0,0xe20330,0x28010
.long 0x840,0x1640,0xe20430,0x2c020,0x848,0x16c0,0xe20530,0x2c030
.long 0x850,0x1750,0xe20630,0x2c000,0x858,0x17d0,0xe20730,0x2c010
.long 0x920,0x1030,0xe20020,0x30030,0x928,0x10b0,0xe20120,0x30020
.long 0x930,0x1120,0xe20220,0x30010,0x938,0x11a0,0xe20320,0x30000
.long 0x9e0,0x1210,0xe20420,0x34030,0x9e8,0x1290,0xe20520,0x34020
.long 0x9f0,0x1300,0xe20620,0x34010,0x9f8,0x1380,0xe20720,0x34000
.long 0xaa0,0x1470,0xe20030,0x38030,0xaa8,0x14f0,0xe20130,0x38020
.long 0xab0,0x1560,0xe20230,0x38010,0xab8,0x15e0,0xe20330,0x38000
.long 0xb60,0x1650,0xe20430,0x3c030,0xb68,0x16d0,0xe20530,0x3c020
.long 0xb70,0x1740,0xe20630,0x3c010,0xb78,0x17c0,0xe20730,0x3c000
.long 0x22200,0x20000,0x0,0x0,0x22240,0x20020,0x10,0x20
.long 0x22280,0x20040,0x20,0x40,0x222c0,0x20060,0x30,0x60
.long 0x22310,0x20080,0x40,0x80,0x22350,0x200a0,0x50,0xa0
.long 0x22390,0x200c0,0x60,0xc0,0x223d0,0x200e0,0x70,0xe0
.long 0x22420,0x20110,0x80,0x100,0x22460,0x20130,0x90,0x120
.long 0x224a0,0x20150,0xa0,0x140,0x224e0,0x20170,0xb0,0x160
.long 0x22530,0x20190,0xc0,0x180,0x22570,0x201b0,0xd0,0x1a0
.long 0x225b0,0x201d0,0xe0,0x1c0,0x225f0,0x201f0,0xf0,0x1e0
.long 0x23200,0x20800,0x110,0x200,0x23240,0x20820,0x100,0x220
.long 0x23280,0x20840,0x130,0x240,0x232c0,0x20860,0x120,0x260
.long 0x23310,0x20880,0x150,0x280,0x23350,0x208a0,0x140,0x2a0
.long 0x23390,0x208c0,0x170,0x2c0,0x233d0,0x208e0,0x160,0x2e0
.long 0x23420,0x20910,0x190,0x300,0x23460,0x20930,0x180,0x320
.long 0x234a0,0x20950,0x1b0,0x340,0x234e0,0x20970,0x1a0,0x360
.long 0x23530,0x20990,0x1d0,0x380,0x23570,0x209b0,0x1c0,0x3a0
.long 0x235b0,0x209d0,0x1f0,0x3c0,0x235f0,0x209f0,0x1e0,0x3e0
.long 0x24200,0x21000,0x200,0x10,0x24240,0x21020,0x210,0x30
.long 0x24280,0x21040,0x220,0x50,0x242c0,0x21060,0x230,0x70
.long 0x24310,0x21080,0x240,0x90,0x24350,0x210a0,0x250,0xb0
.long 0x24390,0x210c0,0x260,0xd0,0x243d0,0x210e0,0x270,0xf0
.long 0x24420,0x21110,0x280,0x110,0x24460,0x21130,0x290,0x130
.long 0x244a0,0x21150,0x2a0,0x150,0x244e0,0x21170,0x2b0,0x170
.long 0x24530,0x21190,0x2c0,0x190,0x24570,0x211b0,0x2d0,0x1b0
.long 0x245b0,0x211d0,0x2e0,0x1d0,0x245f0,0x211f0,0x2f0,0x1f0
.long 0x25200,0x21800,0x310,0x210,0x25240,0x21820,0x300,0x230
.long 0x25280,0x21840,0x330,0x250,0x252c0,0x21860,0x320,0x270
.long 0x25310,0x21880,0x350,0x290,0x25350,0x218a0,0x340,0x2b0
.long 0x25390,0x218c0,0x370,0x2d0,0x253d0,0x218e0,0x360,0x2f0
.long 0x25420,0x21910,0x390,0x310,0x25460,0x21930,0x380,0x330
.long 0x254a0,0x21950,0x3b0,0x350,0x254e0,0x21970,0x3a0,0x370
.long 0x25530,0x21990,0x3d0,0x390,0x25570,0x219b0,0x3c0,0x3b0
.long 0x255b0,0x219d0,0x3f0,0x3d0,0x255f0,0x219f0,0x3e0,0x3f0
.long 0x0,0x0,0x10000,0x10000,0x10,0x8,0x10110,0x10020
.long 0x20,0x10,0x10220,0x10040,0x30,0x18,0x10330,0x10060
.long 0x40,0x80,0x10440,0x10080,0x50,0x88,0x10550,0x100a0
.long 0x60,0x90,0x10660,0x100c0,0x70,0x98,0x10770,0x100e0
.long 0x400,0x140,0x10880,0x10110,0x410,0x148,0x10990,0x10130
.long 0x420,0x150,0x10aa0,0x10150,0x430,0x158,0x10bb0,0x10170
.long 0x440,0x1c0,0x10cc0,0x10190,0x450,0x1c8,0x10dd0,0x101b0
.long 0x460,0x1d0,0x10ee0,0x101d0,0x470,0x1d8,0x10ff0,0x101f0
.long 0x840,0x20,0x11100,0x10220,0x850,0x28,0x11210,0x10240
.long 0x860,0x30,0x11320,0x10260,0x870,0x38,0x11430,0x10280
.long 0x800,0xa0,0x11540,0x102a0,0x810,0xa8,0x11650,0x102c0
.long 0x820,0xb0,0x11760,0x102e0,0x830,0xb8,0x11870,0x10300
.long 0xc40,0x160,0x11980,0x10330,0xc50,0x168,0x11a90,0x10350
.long 0xc60,0x170,0x11ba0,0x10370,0xc70,0x178,0x11cb0,0x10390
.long 0xc00,0x1e0,0x11dc0,0x103b0,0xc10,0x1e8,0x11ed0,0x103d0
.long 0xc20,0x1f0,0x11fe0,0x103f0,0xc30,0x1f8,0x120f0,0x10410
.long 0x1000,0x400,0x10010,0x10440,0x1010,0x408,0x10120,0x10460
.long 0x1020,0x410,0x10230,0x10480,0x1030,0x418,0x10340,0x104a0
.long 0x1040,0x480,0x10450,0x104c0,0x1050,0x488,0x10560,0x104e0
.long 0x1060,0x490,0x10670,0x10500,0x1070,0x498,0x10780,0x10520
.long 0x1400,0x540,0x10890,0x10550,0x1410,0x548,0x109a0,0x10570
.long 0x1420,0x550,0x10ab0,0x10590,0x1430,0x558,0x10bc0,0x105b0
.long 0x1440,0x5c0,0x10cd0,0x105d0,0x1450,0x5c8,0x10de0,0x105f0
.long 0x1460,0x5d0,0x10ef0,0x10610,0x1470,0x5d8,0x11000,0x10630
.long 0x1840,0x420,0x11110,0x10660,0x1850,0x428,0x11220,0x10680
.long 0x1860,0x430,0x11330,0x106a0,0x1870,0x438,0x11440,0x106c0
.long 0x1800,0x4a0,0x11550,0x106e0,0x1810,0x4a8,0x11660,0x10700
.long 0x1820,0x4b0,0x11770,0x10720,0x1830,0x4b8,0x11880,0x10740
.long 0x1c40,0x560,0x11990,0x10770,0x1c50,0x568,0x11aa0,0x10790
.long 0x1c60,0x570,0x11bb0,0x107b0,0x1c70,0x578,0x11cc0,0x107d0
.long 0x1c00,0x5e0,0x11dd0,0x107f0,0x1c10,0x5e8,0x11ee0,0x10810
.long 0x1c20,0x5f0,0x11ff0,0x10830,0x1c30,0x5f8,0x12100,0x10850
.long 0x0,0x0,0x22200,0x20000,0x10,0x10,0x22208,0x20020
.long 0x20,0x10000,0x22210,0x20040,0x30,0x10010,0x22218,0x20060
.long 0x40,0x20000,0x22220,0x20080,0x50,0x20010,0x22228,0x200a0
.long 0x60,0x30000,0x22230,0x200c0,0x70,0x30010,0x22238,0x200e0
.long 0x400,0x40000,0x22240,0x20100,0x410,0x40010,0x22248,0x20120
.long 0x420,0x50000,0x22250,0x20140,0x430,0x50010,0x22258,0x20160
.long 0x440,0x60000,0x22260,0x20180,0x450,0x60010,0x22268,0x201a0
.long 0x460,0x70000,0x22270,0x201c0,0x470,0x70010,0x22278,0x201e0
.long 0x800,0x80000,0x22280,0x20210,0x810,0x80010,0x22288,0x20230
.long 0x820,0x90000,0x22290,0x20250,0x830,0x90010,0x22298,0x20270
.long 0x840,0xa0000,0x222a0,0x20290,0x850,0xa0010,0x222a8,0x202b0
.long 0x860,0xb0000,0x222b0,0x202d0,0x870,0xb0010,0x222b8,0x202f0
.long 0xc00,0xc0000,0x222c0,0x20310,0xc10,0xc0010,0x222c8,0x20330
.long 0xc20,0xd0000,0x222d0,0x20350,0xc30,0xd0010,0x222d8,0x20370
.long 0xc40,0xe0000,0x222e0,0x20390,0xc50,0xe0010,0x222e8,0x203b0
.long 0xc60,0xf0000,0x222f0,0x203d0,0xc70,0xf0010,0x222f8,0x203f0
.long 0x1000,0x100000,0x23200,0x210c0,0x1010,0x100010,0x23208,0x210e0
.long 0x1020,0x110000,0x23210,0x21100,0x1030,0x110010,0x23218,0x21120
.long 0x1040,0x120000,0x23220,0x21140,0x1050,0x120010,0x23228,0x21160
.long 0x1060,0x130000,0x23230,0x21180,0x1070,0x130010,0x23238,0x211a0
.long 0x1400,0x140000,0x23240,0x211c0,0x1410,0x140010,0x23248,0x211e0
.long 0x1420,0x150000,0x23250,0x21200,0x1430,0x150010,0x23258,0x21220
.long 0x1440,0x160000,0x23260,0x21240,0x1450,0x160010,0x23268,0x21260
.long 0x1460,0x170000,0x23270,0x21280,0x1470,0x170010,0x23278,0x212a0
.long 0x1800,0x180000,0x23280,0x212d0,0x1810,0x180010,0x23288,0x212f0
.long 0x1820,0x190000,0x23290,0x21310,0x1830,0x190010,0x23298,0x21330
.long 0x1840,0x1a0000,0x232a0,0x21350,0x1850,0x1a0010,0x232a8,0x21370
.long 0x1860,0x1b0000,0x232b0,0x21390,0x1870,0x1b0010,0x232b8,0x213b0
.long 0x1c00,0x1c0000,0x232c0,0x213d0,0x1c10,0x1c0010,0x232c8,0x213f0
.long 0x1c20,0x1d0000,0x232d0,0x21410,0x1c30,0x1d0010,0x232d8,0x21430
.long 0x1c40,0x1e0000,0x232e0,0x21450,0x1c50,0x1e0010,0x232e8,0x21470
.long 0x1c60,0x1f0000,0x232f0,0x21490,0x1c70,0x1f0010,0x232f8,0x214b0
.long 0x21060,0x201f0,0x20400,0x20610,0x20000,0x20210,0x20420,0x20630
.long 0x20010,0x20220,0x20430,0x20640,0x20020,0x20230,0x20440,0x20650
.long 0x20030,0x20240,0x20450,0x20660,0x20040,0x20250,0x20460,0x20670
.long 0x20050,0x20260,0x20470,0x20680,0x20060,0x20270,0x20480,0x20690
.long 0x20070,0x20280,0x20490,0x206a0,0x20080,0x20290,0x204a0,0x206b0
.long 0x20090,0x202a0,0x204b0,0x206c0,0x200a0,0x202b0,0x204c0,0x206d0
.long 0x200b0,0x202c0,0x204d0,0x206e0,0x200c0,0x202d0,0x204e0,0x206f0
.long 0x200d0,0x202e0,0x204f0,0x20700,0x200e0,0x202f0,0x20500,0x20710
.long 0x20820,0x20a30,0x20c40,0x20e50,0x20840,0x20a50,0x20c60,0x20e70
.long 0x20850,0x20a60,0x20c70,0x20e80,0x20860,0x20a70,0x20c80,0x20e90
.long 0x20870,0x20a80,0x20c90,0x20ea0,0x20880,0x20a90,0x20ca0,0x20eb0
.long 0x20890,0x20aa0,0x20cb0,0x20ec0,0x208a0,0x20ab0,0x20cc0,0x20ed0
.long 0x208b0,0x20ac0,0x20cd0,0x20ee0,0x208c0,0x20ad0,0x20ce0,0x20ef0
.long 0x208d0,0x20ae0,0x20cf0,0x20f00,0x208e0,0x20af0,0x20d00,0x20f10
.long 0x208f0,0x20b00,0x20d10,0x20f20,0x20900,0x20b10,0x20d20,0x20f30
.long 0x20910,0x20b20,0x20d30,0x20f40,0x20920,0x20b30,0x20d40,0x20f50
.long 0x20f60,0x20d50,0x20b40,0x20930,0x21050,0x20e40,0x20c30,0x20a20
.long 0x21040,0x20e30,0x20c20,0x20a10,0x21030,0x20e20,0x20c10,0x20a00
.long 0x21020,0x20e10,0x20c00,0x209f0,0x21010,0x20e00,0x20bf0,0x209e0
.long 0x21000,0x20df0,0x20be0,0x209d0,0x20ff0,0x20de0,0x20bd0,0x209c0
.long 0x20fe0,0x20dd0,0x20bc0,0x209b0,0x20fd0,0x20dc0,0x20bb0,0x209a0
.long 0x20fc0,0x20db0,0x20ba0,0x20990,0x20fb0,0x20da0,0x20b90,0x20980
.long 0x20fa0,0x20d90,0x20b80,0x20970,0x20f90,0x20d80,0x20b70,0x20960
.long 0x20f80,0x20d70,0x20b60,0x20950,0x20f70,0x20d60,0x20b50,0x20940
.long 0x20720,0x20510,0x20300,0x200f0,0x20810,0x20600,0x203f0,0x201e0
.long 0x20800,0x205f0,0x203e0,0x201d0,0x207f0,0x205e0,0x203d0,0x201c0
.long 0x207e0,0x205d0,0x203c0,0x201b0,0x207d0,0x205c0,0x203b0,0x201a0
.long 0x207c0,0x205b0,0x203a0,0x20190,0x207b0,0x205a0,0x20390,0x20180
.long 0x207a0,0x20590,0x20380,0x20170,0x20790,0x20580,0x20370,0x20160
.long 0x20780,0x20570,0x20360,0x20150,0x20770,0x20560,0x20350,0x20140
.long 0x20760,0x20550,0x20340,0x20130,0x20750,0x20540,0x20330,0x20120
.long 0x20740,0x20530,0x20320,0x20110,0x20730,0x20520,0x20310,0x20100
.long 0x3f800000,0x3f800000,0x3f800000,0x3f800000,0x3f800000,0x3f7fec43,0x3f7fb10f,0x3f7f4e6d
.long 0x3f800000,0x3f7fb10f,0x3f7ec46d,0x3f7d3aac,0x3f800000,0x3f7f4e6d,0x3f7d3aac,0x3f79c79d
.long 0x3f800000,0x3f7ec46d,0x3f7b14be,0x3f74fa0b,0x3f800000,0x3f7e1324,0x3f7853f8,0x3f6ed89e
.long 0x3f800000,0x3f7d3aac,0x3f74fa0b,0x3f676bd8,0x3f800000,0x3f7c3b28,0x3f710908,0x3f5ebe05
.long 0x3f800000,0x3f7b14be,0x3f6c835e,0x3f54db31,0x3f800000,0x3f79c79d,0x3f676bd8,0x3f49d112
.long 0x3f800000,0x3f7853f8,0x3f61c598,0x3f3daef9,0x3f800000,0x3f76ba07,0x3f5b941a,0x3f3085bb
.long 0x3f800000,0x3f74fa0b,0x3f54db31,0x3f226799,0x3f800000,0x3f731447,0x3f4d9f02,0x3f13682a
.long 0x3f800000,0x3f710908,0x3f45e403,0x3f039c3d,0x3f800000,0x3f6ed89e,0x3f3daef9,0x3ee63375
.long 0x3f800000,0x3f800000,0x3f800000,0x3f800000,0x3f7ec46d,0x3f7e1324,0x3f7d3aac,0x3f7c3b28
.long 0x3f7b14be,0x3f7853f8,0x3f74fa0b,0x3f710908,0x3f74fa0b,0x3f6ed89e,0x3f676bd8,0x3f5ebe05
.long 0x3f6c835e,0x3f61c598,0x3f54db31,0x3f45e403,0x3f61c598,0x3f514d3d,0x3f3daef9,0x3f273656
.long 0x3f54db31,0x3f3daef9,0x3f226799,0x3f039c3d,0x3f45e403,0x3f273656,0x3f039c3d,0x3eb8442a
.long 0x3f3504f3,0x3f0e39da,0x3ec3ef15,0x3e47c5c2,0x3f226799,0x3ee63375,0x3e78cfcc,0x3cc90ab0
.long 0x3f0e39da,0x3eac7cd4,0x3dc8bd36,0xbe164083,0x3ef15aea,0x3e605c13,0xbd48fb30,0xbea09ae5
.long 0x3ec3ef15,0x3dc8bd36,0xbe47c5c2,0xbef15aea,0x3e94a031,0xbcc90ab0,0xbeac7cd4,0xbf1d7fd1
.long 0x3e47c5c2,0xbe164083,0xbef15aea,0xbf3daef9,0x3dc8bd36,0xbe888e93,0xbf187fc0,0xbf584853
.long 0x3f800000,0x3f800000,0x3f800000,0x3f800000,0x3f7b14be,0x3f79c79d,0x3f7853f8,0x3f76ba07
.long 0x3f6c835e,0x3f676bd8,0x3f61c598,0x3f5b941a,0x3f54db31,0x3f49d112,0x3f3daef9,0x3f3085bb
.long 0x3f3504f3,0x3f226799,0x3f0e39da,0x3ef15aea,0x3f0e39da,0x3ee63375,0x3eac7cd4,0x3e605c13
.long 0x3ec3ef15,0x3e78cfcc,0x3dc8bd36,0xbd48fb30,0x3e47c5c2,0x3cc90ab0,0xbe164083,0xbea09ae5
.long 0x0,0xbe47c5c2,0xbec3ef15,0xbf0e39da,0xbe47c5c2,0xbecf7bca,0xbf187fc0,0xbf41d870
.long 0xbec3ef15,0xbf187fc0,0xbf45e403,0xbf676bd8,0xbf0e39da,0xbf41d870,0xbf676bd8,0xbf7c3b28
.long 0xbf3504f3,0xbf61c598,0xbf7b14be,0xbf7ec46d,0xbf54db31,0xbf76ba07,0xbf7fb10f,0xbf6ed89e
.long 0xbf6c835e,0xbf7fb10f,0xbf74fa0b,0xbf4d9f02,0xbf7b14be,0xbf7c3b28,0xbf5b941a,0xbf1d7fd1
.long 0x3f800000,0x3f800000,0x3f800000,0x3f800000,0x3f74fa0b,0x3f731447,0x3f710908,0x3f6ed89e
.long 0x3f54db31,0x3f4d9f02,0x3f45e403,0x3f3daef9,0x3f226799,0x3f13682a,0x3f039c3d,0x3ee63375
.long 0x3ec3ef15,0x3e94a031,0x3e47c5c2,0x3dc8bd36,0x3dc8bd36,0xbcc90ab0,0xbe164083,0xbe888e93
.long 0xbe47c5c2,0xbeac7cd4,0xbef15aea,0xbf187fc0,0xbef15aea,0xbf1d7fd1,0xbf3daef9,0xbf584853
.long 0xbf3504f3,0xbf54db31,0xbf6c835e,0xbf7b14be,0xbf61c598,0xbf76ba07,0xbf7fb10f,0xbf7c3b28
.long 0xbf7b14be,0xbf7fb10f,0xbf74fa0b,0xbf5b941a,0xbf7ec46d,0xbf6ed89e,0xbf4d9f02,0xbf1d7fd1
.long 0xbf6c835e,0xbf45e403,0xbf0e39da,0xbe94a031,0xbf45e403,0xbf08f59b,0xbe78cfcc,0x3d96a905
.long 0xbf0e39da,0xbe78cfcc,0x3dc8bd36,0x3edae880,0xbe94a031,0x3d96a905,0x3edae880,0x3f396842
.long 0x0,0x0,0x0,0x0,0x0,0x3cc90ab0,0x3d48fb30,0x3d96a905
.long 0x0,0x3d48fb30,0x3dc8bd36,0x3e164083,0x0,0x3d96a905,0x3e164083,0x3e605c13
.long 0x0,0x3dc8bd36,0x3e47c5c2,0x3e94a031,0x0,0x3dfab273,0x3e78cfcc,0x3eb8442a
.long 0x0,0x3e164083,0x3e94a031,0x3edae880,0x0,0x3e2f10a2,0x3eac7cd4,0x3efc5d27
.long 0x0,0x3e47c5c2,0x3ec3ef15,0x3f0e39da,0x0,0x3e605c13,0x3edae880,0x3f1d7fd1
.long 0x0,0x3e78cfcc,0x3ef15aea,0x3f2beb4a,0x0,0x3e888e93,0x3f039c3d,0x3f396842
.long 0x0,0x3e94a031,0x3f0e39da,0x3f45e403,0x0,0x3ea09ae5,0x3f187fc0,0x3f514d3d
.long 0x0,0x3eac7cd4,0x3f226799,0x3f5b941a,0x0,0x3eb8442a,0x3f2beb4a,0x3f64aa59
.long 0x0,0x0,0x0,0x0,0x3dc8bd36,0x3dfab273,0x3e164083,0x3e2f10a2
.long 0x3e47c5c2,0x3e78cfcc,0x3e94a031,0x3eac7cd4,0x3e94a031,0x3eb8442a,0x3edae880,0x3efc5d27
.long 0x3ec3ef15,0x3ef15aea,0x3f0e39da,0x3f226799,0x3ef15aea,0x3f13682a,0x3f2beb4a,0x3f41d870
.long 0x3f0e39da,0x3f2beb4a,0x3f45e403,0x3f5b941a,0x3f226799,0x3f41d870,0x3f5b941a,0x3f6ed89e
.long 0x3f3504f3,0x3f54db31,0x3f6c835e,0x3f7b14be,0x3f45e403,0x3f64aa59,0x3f7853f8,0x3f7fec43
.long 0x3f54db31,0x3f710908,0x3f7ec46d,0x3f7d3aac,0x3f61c598,0x3f79c79d,0x3f7fb10f,0x3f731447
.long 0x3f6c835e,0x3f7ec46d,0x3f7b14be,0x3f61c598,0x3f74fa0b,0x3f7fec43,0x3f710908,0x3f49d112
.long 0x3f7b14be,0x3f7d3aac,0x3f61c598,0x3f2beb4a,0x3f7ec46d,0x3f76ba07,0x3f4d9f02,0x3f08f59b
.long 0x0,0x0,0x0,0x0,0x3e47c5c2,0x3e605c13,0x3e78cfcc,0x3e888e93
.long 0x3ec3ef15,0x3edae880,0x3ef15aea,0x3f039c3d,0x3f0e39da,0x3f1d7fd1,0x3f2beb4a,0x3f396842
.long 0x3f3504f3,0x3f45e403,0x3f54db31,0x3f61c598,0x3f54db31,0x3f64aa59,0x3f710908,0x3f79c79d
.long 0x3f6c835e,0x3f7853f8,0x3f7ec46d,0x3f7fb10f,0x3f7b14be,0x3f7fec43,0x3f7d3aac,0x3f731447
.long 0x3f800000,0x3f7b14be,0x3f6c835e,0x3f54db31,0x3f7b14be,0x3f6a09a7,0x3f4d9f02,0x3f273656
.long 0x3f6c835e,0x3f4d9f02,0x3f226799,0x3edae880,0x3f54db31,0x3f273656,0x3edae880,0x3e2f10a2
.long 0x3f3504f3,0x3ef15aea,0x3e47c5c2,0xbdc8bd36,0x3f0e39da,0x3e888e93,0xbd48fb30,0xbeb8442a
.long 0x3ec3ef15,0x3d48fb30,0xbe94a031,0xbf187fc0,0x3e47c5c2,0xbe2f10a2,0xbf039c3d,0xbf49d112
.long 0x0,0x0,0x0,0x0,0x3e94a031,0x3ea09ae5,0x3eac7cd4,0x3eb8442a
.long 0x3f0e39da,0x3f187fc0,0x3f226799,0x3f2beb4a,0x3f45e403,0x3f514d3d,0x3f5b941a,0x3f64aa59
.long 0x3f6c835e,0x3f74fa0b,0x3f7b14be,0x3f7ec46d,0x3f7ec46d,0x3f7fec43,0x3f7d3aac,0x3f76ba07
.long 0x3f7b14be,0x3f710908,0x3f61c598,0x3f4d9f02,0x3f61c598,0x3f49d112,0x3f2beb4a,0x3f08f59b
.long 0x3f3504f3,0x3f0e39da,0x3ec3ef15,0x3e47c5c2,0x3ef15aea,0x3e888e93,0x3d48fb30,0xbe2f10a2
.long 0x3e47c5c2,0xbd48fb30,0xbe94a031,0xbf039c3d,0xbdc8bd36,0xbeb8442a,0xbf187fc0,0xbf49d112
.long 0xbec3ef15,0xbf226799,0xbf54db31,0xbf74fa0b,0xbf226799,0xbf584853,0xbf7853f8,0xbf7f4e6d
.long 0xbf54db31,0xbf7853f8,0xbf7ec46d,0xbf676bd8,0xbf74fa0b,0xbf7f4e6d,0xbf676bd8,0xbf3085bb
.long 0x36003600,0x80003600,0x80003600,0x80003600,0xb6003600,0xb4c835fb,0xb54435ed,0xb58e35d5
.long 0x36003600,0xb54435ed,0xb5b535b5,0xb5ed3544,0xb6003600,0xb58e35d5,0xb5ed3544,0xb5fbb4c8
.long 0x36003600,0xb5b535b5,0xb6000000,0xb5b5b5b5,0xb6003600,0xb5d5358e,0xb5edb544,0xb4c8b5fb
.long 0x36003600,0xb5ed3544,0xb5b5b5b5,0x3544b5ed,0xb6003600,0xb5fb34c8,0xb544b5ed,0x35d5b58e
.long 0x36003600,0xb6000000,0x8000b600,0x36000000,0xb6003600,0xb5fbb4c8,0x3544b5ed,0x35d5358e
.long 0x36003600,0xb5edb544,0x35b5b5b5,0x354435ed,0xb6003600,0xb5d5b58e,0x35edb544,0xb4c835fb
.long 0x36003600,0xb5b5b5b5,0x36000000,0xb5b535b5,0xb6003600,0xb58eb5d5,0x35ed3544,0xb5fb34c8
.long 0x36003600,0xb544b5ed,0x35b535b5,0xb5edb544,0xb6003600,0xb4c8b5fb,0x354435ed,0xb58eb5d5
.long 0x80003600,0x80003600,0x80003600,0x80003600,0xb5b535b5,0xb5d5358e,0xb5ed3544,0xb5fb34c8
.long 0xb6000000,0xb5edb544,0xb5b5b5b5,0xb544b5ed,0xb5b5b5b5,0xb4c8b5fb,0x3544b5ed,0x35d5b58e
.long 0x8000b600,0x35b5b5b5,0x36000000,0x35b535b5,0x35b5b5b5,0x35fb34c8,0x354435ed,0xb58e35d5
.long 0x36000000,0x354435ed,0xb5b535b5,0xb5edb544,0x35b535b5,0xb58e35d5,0xb5edb544,0x34c8b5fb
.long 0x80003600,0xb6000000,0x8000b600,0x36000000,0xb5b535b5,0xb58eb5d5,0x35edb544,0x34c835fb
.long 0xb6000000,0x3544b5ed,0x35b535b5,0xb5ed3544,0xb5b5b5b5,0x35fbb4c8,0xb54435ed,0xb58eb5d5
.long 0x8000b600,0x35b535b5,0xb6000000,0x35b5b5b5,0x35b5b5b5,0xb4c835fb,0xb544b5ed,0x35d5358e
.long 0x36000000,0xb5ed3544,0x35b5b5b5,0xb54435ed,0x35b535b5,0xb5d5b58e,0x35ed3544,0xb5fbb4c8
.long 0x80003600,0x80003600,0x80003600,0x80003600,0xb6000000,0xb5fbb4c8,0xb5edb544,0xb5d5b58e
.long 0x8000b600,0x3544b5ed,0x35b5b5b5,0x35edb544,0x36000000,0x35d5358e,0x354435ed,0xb4c835fb
.long 0x80003600,0xb5b535b5,0xb6000000,0xb5b5b5b5,0xb6000000,0xb58eb5d5,0x3544b5ed,0x35fbb4c8
.long 0x8000b600,0x35edb544,0x35b535b5,0xb54435ed,0x36000000,0x34c835fb,0xb5ed3544,0xb58eb5d5
.long 0x80003600,0xb6000000,0x8000b600,0x36000000,0xb6000000,0x34c8b5fb,0x35ed3544,0xb58e35d5
.long 0x8000b600,0x35ed3544,0xb5b535b5,0xb544b5ed,0x36000000,0xb58e35d5,0xb544b5ed,0x35fb34c8
.long 0x80003600,0xb5b5b5b5,0x36000000,0xb5b535b5,0xb6000000,0x35d5b58e,0xb54435ed,0xb4c8b5fb
.long 0x8000b600,0x354435ed,0xb5b5b5b5,0x35ed3544,0x36000000,0xb5fb34c8,0x35edb544,0xb5d5358e
.long 0x80003600,0x80003600,0x80003600,0x80003600,0xb5b5b5b5,0xb58eb5d5,0xb544b5ed,0xb4c8b5fb
.long 0x36000000,0x35ed3544,0x35b535b5,0x354435ed,0xb5b535b5,0xb5fb34c8,0xb5edb544,0xb58eb5d5
.long 0x8000b600,0x35b5b5b5,0x36000000,0x35b535b5,0x35b535b5,0xb4c835fb,0xb5ed3544,0xb5d5b58e
.long 0xb6000000,0xb544b5ed,0x35b5b5b5,0x35ed3544,0x35b5b5b5,0x35d5358e,0xb54435ed,0xb5fbb4c8
.long 0x80003600,0xb6000000,0x8000b600,0x36000000,0xb5b5b5b5,0x35d5b58e,0x354435ed,0xb5fb34c8
.long 0x36000000,0xb54435ed,0xb5b5b5b5,0x35edb544,0xb5b535b5,0xb4c8b5fb,0x35ed3544,0xb5d5358e
.long 0x8000b600,0x35b535b5,0xb6000000,0x35b5b5b5,0x35b535b5,0xb5fbb4c8,0x35edb544,0xb58e35d5
.long 0xb6000000,0x35edb544,0xb5b535b5,0x3544b5ed,0x35b5b5b5,0xb58e35d5,0x3544b5ed,0xb4c835fb
.long 0x36003600,0x8000b600,0x80003600,0x8000b600,0xb6003600,0x34c8b5fb,0xb54435ed,0x358eb5d5
.long 0x36003600,0x3544b5ed,0xb5b535b5,0x35edb544,0xb6003600,0x358eb5d5,0xb5ed3544,0x35fb34c8
.long 0x36003600,0x35b5b5b5,0xb6000000,0x35b535b5,0xb6003600,0x35d5b58e,0xb5edb544,0x34c835fb
.long 0x36003600,0x35edb544,0xb5b5b5b5,0xb54435ed,0xb6003600,0x35fbb4c8,0xb544b5ed,0xb5d5358e
.long 0x36003600,0x36000000,0x8000b600,0xb6000000,0xb6003600,0x35fb34c8,0x3544b5ed,0xb5d5b58e
.long 0x36003600,0x35ed3544,0x35b5b5b5,0xb544b5ed,0xb6003600,0x35d5358e,0x35edb544,0x34c8b5fb
.long 0x36003600,0x35b535b5,0x36000000,0x35b5b5b5,0xb6003600,0x358e35d5,0x35ed3544,0x35fbb4c8
.long 0x36003600,0x354435ed,0x35b535b5,0x35ed3544,0xb6003600,0x34c835fb,0x354435ed,0x358e35d5
.long 0x80003600,0x8000b600,0x80003600,0x8000b600,0xb5b535b5,0x35d5b58e,0xb5ed3544,0x35fbb4c8
.long 0xb6000000,0x35ed3544,0xb5b5b5b5,0x354435ed,0xb5b5b5b5,0x34c835fb,0x3544b5ed,0xb5d5358e
.long 0x8000b600,0xb5b535b5,0x36000000,0xb5b5b5b5,0x35b5b5b5,0xb5fbb4c8,0x354435ed,0x358eb5d5
.long 0x36000000,0xb544b5ed,0xb5b535b5,0x35ed3544,0x35b535b5,0x358eb5d5,0xb5edb544,0xb4c835fb
.long 0x80003600,0x36000000,0x8000b600,0xb6000000,0xb5b535b5,0x358e35d5,0x35edb544,0xb4c8b5fb
.long 0xb6000000,0xb54435ed,0x35b535b5,0x35edb544,0xb5b5b5b5,0xb5fb34c8,0xb54435ed,0x358e35d5
.long 0x8000b600,0xb5b5b5b5,0xb6000000,0xb5b535b5,0x35b5b5b5,0x34c8b5fb,0xb544b5ed,0xb5d5b58e
.long 0x36000000,0x35edb544,0x35b5b5b5,0x3544b5ed,0x35b535b5,0x35d5358e,0x35ed3544,0x35fb34c8
.long 0x80003600,0x8000b600,0x80003600,0x8000b600,0xb6000000,0x35fb34c8,0xb5edb544,0x35d5358e
.long 0x8000b600,0xb54435ed,0x35b5b5b5,0xb5ed3544,0x36000000,0xb5d5b58e,0x354435ed,0x34c8b5fb
.long 0x80003600,0x35b5b5b5,0xb6000000,0x35b535b5,0xb6000000,0x358e35d5,0x3544b5ed,0xb5fb34c8
.long 0x8000b600,0xb5ed3544,0x35b535b5,0x3544b5ed,0x36000000,0xb4c8b5fb,0xb5ed3544,0x358e35d5
.long 0x80003600,0x36000000,0x8000b600,0xb6000000,0xb6000000,0xb4c835fb,0x35ed3544,0x358eb5d5
.long 0x8000b600,0xb5edb544,0xb5b535b5,0x354435ed,0x36000000,0x358eb5d5,0xb544b5ed,0xb5fbb4c8
.long 0x80003600,0x35b535b5,0x36000000,0x35b5b5b5,0xb6000000,0xb5d5358e,0xb54435ed,0x34c835fb
.long 0x8000b600,0xb544b5ed,0xb5b5b5b5,0xb5edb544,0x36000000,0x35fbb4c8,0x35edb544,0x35d5b58e
.long 0x80003600,0x8000b600,0x80003600,0x8000b600,0xb5b5b5b5,0x358e35d5,0xb544b5ed,0x34c835fb
.long 0x36000000,0xb5edb544,0x35b535b5,0xb544b5ed,0xb5b535b5,0x35fbb4c8,0xb5edb544,0x358e35d5
.long 0x8000b600,0xb5b535b5,0x36000000,0xb5b5b5b5,0x35b535b5,0x34c8b5fb,0xb5ed3544,0x35d5358e
.long 0xb6000000,0x354435ed,0x35b5b5b5,0xb5edb544,0x35b5b5b5,0xb5d5b58e,0xb54435ed,0x35fb34c8
.long 0x80003600,0x36000000,0x8000b600,0xb6000000,0xb5b5b5b5,0xb5d5358e,0x354435ed,0x35fbb4c8
.long 0x36000000,0x3544b5ed,0xb5b5b5b5,0xb5ed3544,0xb5b535b5,0x34c835fb,0x35ed3544,0x35d5b58e
.long 0x8000b600,0xb5b5b5b5,0xb6000000,0xb5b535b5,0x35b535b5,0x35fb34c8,0x35edb544,0x358eb5d5
.long 0xb6000000,0xb5ed3544,0xb5b535b5,0xb54435ed,0x35b5b5b5,0x358eb5d5,0x3544b5ed,0x34c8b5fb
.long 0x80003f00,0x80003f80,0x80003f80,0x80003f80,0x8000bf00,0xbec43f6d,0xbf353f35,0xbf6d3ec4
.long 0x80003f00,0xbf353f35,0xbf800000,0xbf35bf35,0x8000bf00,0xbf6d3ec4,0xbf35bf35,0x3ec4bf6d
.long 0x80003f00,0xbf800000,0x8000bf80,0x3f800000,0x8000bf00,0xbf6dbec4,0x3f35bf35,0x3ec43f6d
.long 0x80003f00,0xbf35bf35,0x3f800000,0xbf353f35,0x8000bf00,0xbec4bf6d,0x3f353f35,0xbf6dbec4
.long 0x80003f00,0x8000bf80,0x80003f80,0x8000bf80,0x8000bf00,0x3ec4bf6d,0xbf353f35,0x3f6dbec4
.long 0x80003f00,0x3f35bf35,0xbf800000,0x3f353f35,0x8000bf00,0x3f6dbec4,0xbf35bf35,0xbec43f6d
.long 0x80003f00,0x3f800000,0x8000bf80,0xbf800000,0x8000bf00,0x3f6d3ec4,0x3f35bf35,0xbec4bf6d
.long 0x80003f00,0x3f353f35,0x3f800000,0x3f35bf35,0x8000bf00,0x3ec43f6d,0x3f353f35,0x3f6d3ec4
.long 0x80003f80,0x80003f80,0x80003f80,0x80003f80,0xbf800000,0xbf6dbec4,0xbf35bf35,0xbec4bf6d
.long 0x8000bf80,0x3f35bf35,0x3f800000,0x3f353f35,0x3f800000,0x3ec43f6d,0xbf353f35,0xbf6dbec4
.long 0x80003f80,0xbf800000,0x8000bf80,0x3f800000,0xbf800000,0x3ec4bf6d,0x3f353f35,0xbf6d3ec4
.long 0x8000bf80,0x3f353f35,0xbf800000,0x3f35bf35,0x3f800000,0xbf6d3ec4,0x3f35bf35,0xbec43f6d
.long 0x80003f80,0x8000bf80,0x80003f80,0x8000bf80,0xbf800000,0x3f6d3ec4,0xbf35bf35,0x3ec43f6d
.long 0x8000bf80,0xbf353f35,0x3f800000,0xbf35bf35,0x3f800000,0xbec4bf6d,0xbf353f35,0x3f6d3ec4
.long 0x80003f80,0x3f800000,0x8000bf80,0xbf800000,0xbf800000,0xbec43f6d,0x3f353f35,0x3f6dbec4
.long 0x8000bf80,0xbf35bf35,0xbf800000,0xbf353f35,0x3f800000,0x3f6dbec4,0x3f35bf35,0x3ec4bf6d
.long 0x0,0x0,0x0,0x0,0x0,0x0,0x0,0x0
.long 0x0,0x0,0x0,0x0,0x0,0x0,0x0,0x0
.long 0x0,0x0,0x0,0x0,0x0,0x0,0x0,0x0
.long 0x0,0x0,0x0,0x0,0x0,0x0,0x0,0x0
.long 0x0,0x0,0x0,0x0,0x0,0x0,0x0,0x0
.long 0x0,0x0,0x0,0x0,0x0,0x0,0x0,0x0
.long 0x0,0x0,0x0,0x0,0x0,0x0,0x0,0x0
.long 0x0,0x0,0x0,0x0,0x0,0x0,0x0,0x0
.long 0x0,0x0,0x0,0x0,0x0,0x0,0x0,0x0
.long 0x0,0x0,0x0,0x0,0x0,0x0,0x0,0x0
.long 0x0,0x0,0x0,0x0,0x0,0x0,0x0,0x0
.long 0x0,0x0,0x0,0x0,0x0,0x0,0x0,0x0
.long 0x0,0x0,0x0,0x0,0x0,0x0,0x0,0x0
.long 0x0,0x0,0x0,0x0,0x0,0x0,0x0,0x0
.long 0x0,0x0,0x0,0x0,0x0,0x0,0x0,0x0
.long 0x0,0x0,0x0,0x0,0x0,0x0,0x0,0x0
.long 0x0,0x0,0x0,0x0,0x0,0x0,0x0,0x0
.long 0x0,0x0,0x0,0x0,0x0,0x0,0x0,0x0
.long 0x0,0x0,0x0,0x0,0x0,0x0,0x0,0x0
.long 0x0,0x0,0x0,0x0,0x0,0x0,0x0,0x0
.long 0x0,0x0,0x0,0x0,0x0,0x0,0x0,0x0
.long 0x0,0x0,0x0,0x0,0x0,0x0,0x0,0x0
.long 0x0,0x0,0x0,0x0,0x0,0x0,0x0,0x0
.long 0x0,0x0,0x0,0x0,0x0,0x0,0x0,0x0
.long 0x0,0x0,0x0,0x0,0x0,0x0,0x0,0x0
.long 0x0,0x0,0x0,0x0,0x0,0x0,0x0,0x0
.long 0x0,0x0,0x0,0x0,0x0,0x0,0x0,0x0
.long 0x0,0x0,0x0,0x0,0x0,0x0,0x0,0x0
.long 0x0,0x0,0x0,0x0,0x0,0x0,0x0,0x0
.long 0x0,0x0,0x0,0x0,0x0,0x0,0x0,0x0
.long 0x0,0x0,0x0,0x0,0x0,0x0,0x0,0x0
.long 0x0,0x0,0x0,0x0,0x0,0x0,0x0,0x0
.long 0x3f80,0x3f80,0x3f80,0x3f80,0xbe48bf7b,0xbf0ebf55,0xbf55bf0e,0xbf7bbe48
.long 0x3ec43f6d,0x3f6d3ec4,0x3f6dbec4,0x3ec4bf6d,0xbf0ebf55,0xbf7b3e48,0xbe483f7b,0x3f553f0e
.long 0x3f353f35,0x3f35bf35,0xbf35bf35,0xbf353f35,0xbf55bf0e,0xbe483f7b,0x3f7bbe48,0xbf0ebf55
.long 0x3f6d3ec4,0xbec4bf6d,0xbec43f6d,0x3f6dbec4,0xbf7bbe48,0x3f553f0e,0xbf0ebf55,0x3e483f7b
.long 0x3f800000,0xbf800000,0x3f800000,0xbf800000,0xbf7b3e48,0x3f55bf0e,0xbf0e3f55,0x3e48bf7b
.long 0x3f6dbec4,0xbec43f6d,0xbec4bf6d,0x3f6d3ec4,0xbf553f0e,0xbe48bf7b,0x3f7b3e48,0xbf0e3f55
.long 0x3f35bf35,0x3f353f35,0xbf353f35,0xbf35bf35,0xbf0e3f55,0xbf7bbe48,0xbe48bf7b,0x3f55bf0e
.long 0x3ec4bf6d,0x3f6dbec4,0x3f6d3ec4,0x3ec43f6d,0xbe483f7b,0xbf0e3f55,0xbf553f0e,0xbf7b3e48
.long 0x3f80,0x3f80,0x3f80,0x3f80,0xbf7b3e48,0xbf553f0e,0xbf0e3f55,0xbe483f7b
.long 0xbec4bf6d,0xbf6dbec4,0xbf6d3ec4,0xbec43f6d,0x3f55bf0e,0xbe48bf7b,0xbf7bbe48,0xbf0e3f55
.long 0x3f353f35,0x3f35bf35,0xbf35bf35,0xbf353f35,0xbf0e3f55,0x3f7b3e48,0xbe48bf7b,0xbf553f0e
.long 0xbf6dbec4,0x3ec43f6d,0x3ec4bf6d,0xbf6d3ec4,0x3e48bf7b,0xbf0e3f55,0x3f55bf0e,0xbf7b3e48
.long 0x3f800000,0xbf800000,0x3f800000,0xbf800000,0x3e483f7b,0xbf0ebf55,0x3f553f0e,0xbf7bbe48
.long 0xbf6d3ec4,0x3ec4bf6d,0x3ec43f6d,0xbf6dbec4,0xbf0ebf55,0x3f7bbe48,0xbe483f7b,0xbf55bf0e
.long 0x3f35bf35,0x3f353f35,0xbf353f35,0xbf35bf35,0x3f553f0e,0xbe483f7b,0xbf7b3e48,0xbf0ebf55
.long 0xbec43f6d,0xbf6d3ec4,0xbf6dbec4,0xbec4bf6d,0xbf7bbe48,0xbf55bf0e,0xbf0ebf55,0xbe48bf7b
```
